```python
import torch

def _softmax(x, axis=-1):
    return torch.softmax(x, dim=axis)

def _gelu(x):
    return torch.nn.functional.gelu(x, approximate='tanh')

def _silu(x):
    return torch.nn.functional.silu(x)

def _sigmoid(x):
    return torch.sigmoid(x)

def _layernorm(x, axis=-1, eps=1e-05):
    m = x.mean(dim=axis, keepdim=True)
    v = x.var(dim=axis, keepdim=True, unbiased=False)
    return (x - m) / torch.sqrt(v + eps)

def _scatter_add(tgt, idx, src, axis=0):
    return tgt.clone().index_add_(axis, idx, src)

def _segment_sum(src, seg, n):
    out = torch.zeros((n,) + src.shape[1:], dtype=src.dtype)
    return out.index_add_(0, seg, src)

def _pad(x, pw):
    flat = tuple((v for pair in reversed(pw) for v in pair))
    return torch.nn.functional.pad(x, flat)
kernel_name = 'standalone__molecular_angular_painn__graph'

def setup_inputs():

    _w = lambda a: (lambda t: t.to(torch.bfloat16) if t.is_floating_point() else t)(torch.as_tensor(a))
    N, deg, D = (10000, 32, 128)
    n_rbf = max(16, 4)
    E = N * deg
    cutoff = 5.0
    freqs = (torch.arange(1, n_rbf + 1) * torch.pi / cutoff).to(float)
    return {'sv': _w((lambda *s: torch.randn(*s, dtype=torch.bfloat16) * 0.4)(N, 4, D) * 0.3), 'pos': _w((lambda *s: torch.randn(*s, dtype=torch.bfloat16) * 1.6)(N, 3) * 1.2), 'src': _w((lambda lo, hi, *s: torch.randint(lo, hi, s))(0, N, E).to(torch.int64)), 'dst': _w((lambda lo, hi, *s: torch.randint(lo, hi, s))(0, N, E).to(torch.int64)), 'freqs': _w(freqs), 'w_phi1': _w((lambda *s: torch.randn(*s, dtype=torch.bfloat16) * 3.2)(D, D) / D ** 0.5), 'w_phi2': _w((lambda *s: torch.randn(*s, dtype=torch.bfloat16) * 1.6)(D, 3 * D) / D ** 0.5), 'w_rbf': _w((lambda *s: torch.randn(*s, dtype=torch.bfloat16) * 1.6)(n_rbf, 3 * D) / n_rbf ** 0.5)}

def reference(sv, pos, src, dst, freqs, w_phi1, w_phi2, w_rbf):
    N, _, D = sv.shape
    E = src.shape[0]
    PI, cutoff = (3.141592653589793, 5.0)
    s, v = (sv[:, 0, :].clone(), sv[:, 1:, :].clone())
    r_vec = pos[src] - pos[dst]
    d = torch.sqrt((r_vec * r_vec).sum(-1) + 1e-08)
    r_hat = r_vec / d[:, None]
    rbf = torch.sin(d[:, None] * freqs[None, :]) / d[:, None]
    fcut = 0.5 * (torch.cos(PI * d / cutoff) + 1.0)
    fcut = torch.where(d < cutoff, fcut, 0.0 * d)
    Wf = rbf @ w_rbf * fcut[:, None]
    phi = (_silu(s @ w_phi1) @ w_phi2)[src]
    m = phi * Wf
    m_s, m_vv, m_vr = (m[:, :D].clone(), m[:, D:2 * D].clone(), m[:, 2 * D:].clone())
    ds = _segment_sum(m_s, dst, N)
    dv_e = m_vv[:, None, :] * v[src] + m_vr[:, None, :] * r_hat[:, :, None]
    dv = _segment_sum(dv_e.reshape(E, 3 * D), dst, N).reshape(N, 3, D)
    return sv + torch.concatenate([ds[:, None, :], dv], axis=1)
```

```asm
; @launch kernel=standalone__molecular_angular_painn__graph_kernel grid=(256,1,1) block=(1024,1,1) lds=163840
.amdgcn_target "amdgcn-amd-amdhsa--gfx950"
.text
.globl standalone__molecular_angular_painn__graph_kernel
.p2align 8
.type standalone__molecular_angular_painn__graph_kernel,@function
standalone__molecular_angular_painn__graph_kernel:
    s_cmp_ge_u32 s2, 256
    s_cbranch_scc1 L_end
    s_load_dwordx16 s[4:19], s[0:1], 0
    s_load_dwordx2 s[20:21], s[0:1], 80
    v_and_b32 v1, 63, v0
    v_lshrrev_b32 v2, 6, v0
    s_nop 0
    v_readfirstlane_b32 s22, v2
    s_load_dwordx2 s[76:77], s[0:1], 72
    s_load_dwordx2 s[100:101], s[0:1], 64
    v_lshlrev_b32 v2, 4, v1
    v_add_u32 v2, 162816, v2
    v_mov_b32 v4, 0
    v_mov_b32 v5, 0
    v_mov_b32 v6, 0
    v_mov_b32 v7, 0
    ds_write_b128 v2, v[4:7]
    s_mov_b32 s78, 256
    s_mov_b32 s79, 0x00020000
    s_mov_b32 s74, 49152
    s_mov_b32 s75, 0x00020000
    s_waitcnt lgkmcnt(0)
    s_add_u32 s72, s20, 69206016
    s_addc_u32 s73, s21, 0
    s_cmp_ge_u32 s2, 157
    s_cbranch_scc1 L_k1_other
    v_lshrrev_b32 v2, 4, v0
    v_and_b32 v3, 15, v0
    s_lshl_b32 s23, s2, 6
    v_add_u32 v33, s23, v2
    v_lshlrev_b32 v4, 10, v33
    v_lshl_add_u32 v4, v3, 4, v4
    v_lshrrev_b32 v34, 4, v1
    s_lshr_b32 s49, s2, 3
    s_mul_i32 s49, s49, 1
    s_add_u32 s49, s49, s22
    s_and_b32 s49, s49, 15
    s_and_b32 s40, s49, 1
    s_lshl_b32 s40, s40, 2
    v_or_b32 v5, s40, v34
    v_lshlrev_b32 v5, 1, v5
    v_xor_b32 v5, v5, v3
    v_lshlrev_b32 v35, 4, v5
    s_lshl_b32 s41, s49, 3
    v_add_u32 v6, s41, v34
    v_lshl_add_u32 v5, v6, 8, v35
    v_mul_u32_u24 v6, 0x300, v6
    v_add_u32 v6, v6, v35
    s_lshl_b32 s42, s49, 11
    s_movk_i32 s43, 0x100
    s_movk_i32 s44, 0x200
    s_movk_i32 s45, 0x800
    s_movk_i32 s46, 0x900
    s_movk_i32 s47, 0xa00
    s_mov_b32 m0, s42
    s_waitcnt lgkmcnt(0)
    s_mov_b32 s24, s4
    s_mov_b32 s25, s5
    s_mov_b32 s26, 10240000
    s_mov_b32 s27, 0x00020000
    s_mov_b32 s28, s14
    s_mov_b32 s29, s15
    s_mov_b32 s30, 32768
    s_mov_b32 s31, 0x00020000
    s_mov_b32 s32, s16
    s_mov_b32 s33, s17
    s_mov_b32 s34, 98304
    s_mov_b32 s35, 0x00020000
    s_mov_b32 s36, s20
    s_mov_b32 s37, s21
    s_mov_b32 s38, 12800000
    s_mov_b32 s39, 0x00020000
    buffer_load_dwordx4 v[8:11], v4, s[24:27], 0 offen
    buffer_load_dwordx4 v5, s[28:31], 0 offen lds
    buffer_load_dwordx4 v5, s[28:31], 0 offen offset:1024 lds
    s_add_u32 s48, s42, 0x8000
    s_mov_b32 m0, s48
    s_add_u32 s48, s42, 0x10000
    buffer_load_dwordx4 v6, s[32:35], 0 offen lds
    buffer_load_dwordx4 v6, s[32:35], s45 offen offset:1024 lds
    s_mov_b32 m0, s48
    s_add_u32 s48, s42, 0x18000
    buffer_load_dwordx4 v6, s[32:35], s43 offen lds
    buffer_load_dwordx4 v6, s[32:35], s46 offen offset:1024 lds
    s_mov_b32 m0, s48
    s_nop 0
    buffer_load_dwordx4 v6, s[32:35], s44 offen lds
    buffer_load_dwordx4 v6, s[32:35], s47 offen offset:1024 lds
    v_and_b32 v7, 15, v2
    v_xor_b32 v7, v7, v3
    v_lshlrev_b32 v7, 4, v7
    v_lshl_add_u32 v7, v2, 8, v7
    v_add_u32 v24, 0x20000, v7
    s_and_b32 s40, s22, 3
    s_lshl_b32 s40, s40, 1
    s_lshr_b32 s41, s22, 2
    v_bfe_u32 v25, v1, 2, 3
    v_xor_b32 v25, s40, v25
    v_lshlrev_b32 v25, 5, v25
    v_and_b32 v26, 3, v1
    v_lshl_add_u32 v25, v26, 3, v25
    v_bfe_u32 v26, v1, 2, 2
    v_lshl_add_u32 v26, v34, 3, v26
    v_lshl_add_u32 v25, v26, 8, v25
    v_xor_b32 v26, 32, v25
    v_add_u32 v5, 0x10000, v25
    v_add_u32 v6, 0x10000, v26
    s_lshl_b32 s48, s41, 12
    v_lshlrev_b32 v27, 8, v3
    v_add_u32 v27, s48, v27
    v_xor_b32 v28, v34, v3
    v_lshl_add_u32 v28, v28, 4, v27
    v_add_u32 v28, 0x20000, v28
    v_xor_b32 v29, 64, v28
    v_xor_b32 v30, 0x80, v28
    v_xor_b32 v31, 0xc0, v28
    s_lshl_b32 s48, s40, 1
    v_lshrrev_b32 v32, 1, v34
    v_add_u32 v32, s48, v32
    v_xor_b32 v32, v32, v3
    v_lshl_add_u32 v27, v32, 4, v27
    v_and_b32 v32, 1, v34
    v_lshl_add_u32 v27, v32, 3, v27
    v_lshlrev_b32 v35, 2, v3
    v_add_u32 v35, 0x24000, v35
    v_mov_b32 v32, 0
    ds_write_b32 v35, v32
    s_lshl_b32 s48, s41, 4
    s_add_u32 s48, s48, 0x24000
    v_mov_b32 v35, s48
    v_mov_b32 v32, 1
    v_lshlrev_b32 v2, 4, v1
    v_add_u32 v2, 0x24000, v2
    s_waitcnt vmcnt(8)
    ds_write_b128 v24, v[8:11]
    s_waitcnt vmcnt(0) lgkmcnt(0)
    s_barrier
    ds_read_b128 v[84:87], v28
    ds_read_b64_tr_b16 v[36:37], v25 offset:0
    ds_read_b64_tr_b16 v[38:39], v25 offset:1024
    ds_read_b64_tr_b16 v[52:53], v26 offset:0
    ds_read_b64_tr_b16 v[54:55], v26 offset:1024
    ds_read_b128 v[88:91], v29
    ds_read_b64_tr_b16 v[40:41], v25 offset:8192
    ds_read_b64_tr_b16 v[42:43], v25 offset:9216
    ds_read_b64_tr_b16 v[56:57], v26 offset:8192
    ds_read_b64_tr_b16 v[58:59], v26 offset:9216
    buffer_load_dwordx4 v[12:15], v4, s[24:27], 0 offen offset:256
    buffer_load_dwordx4 v[16:19], v4, s[24:27], 0 offen offset:512
    buffer_load_dwordx4 v[20:23], v4, s[24:27], 0 offen offset:768
    v_xor_b32 v8, 32, v27
    v_add_u32 v9, 0x20000, v27
    v_add_u32 v10, 0x20000, v8
    ds_read_b128 v[92:95], v30
    ds_read_b64_tr_b16 v[44:45], v25 offset:16384
    ds_read_b64_tr_b16 v[46:47], v25 offset:17408
    ds_read_b64_tr_b16 v[60:61], v26 offset:16384
    ds_read_b64_tr_b16 v[62:63], v26 offset:17408
    ds_read_b128 v[96:99], v31
    ds_read_b64_tr_b16 v[48:49], v25 offset:24576
    ds_read_b64_tr_b16 v[50:51], v25 offset:25600
    ds_read_b64_tr_b16 v[64:65], v26 offset:24576
    ds_read_b64_tr_b16 v[66:67], v26 offset:25600
    s_waitcnt lgkmcnt(15)
    v_mfma_f32_16x16x32_bf16 v[100:103], v[36:39], v[84:87], 0
    v_mfma_f32_16x16x32_bf16 v[104:107], v[52:55], v[84:87], 0
    s_waitcnt lgkmcnt(10)
    v_mfma_f32_16x16x32_bf16 v[100:103], v[40:43], v[88:91], v[100:103]
    v_mfma_f32_16x16x32_bf16 v[104:107], v[56:59], v[88:91], v[104:107]
    s_waitcnt lgkmcnt(5)
    v_mfma_f32_16x16x32_bf16 v[100:103], v[44:47], v[92:95], v[100:103]
    v_mfma_f32_16x16x32_bf16 v[104:107], v[60:63], v[92:95], v[104:107]
    s_waitcnt lgkmcnt(0)
    v_mfma_f32_16x16x32_bf16 v[100:103], v[48:51], v[96:99], v[100:103]
    v_mfma_f32_16x16x32_bf16 v[104:107], v[64:67], v[96:99], v[104:107]
    s_barrier
    ds_read_b64_tr_b16 v[68:69], v5 offset:0
    ds_read_b64_tr_b16 v[70:71], v5 offset:1024
    ds_read_b64_tr_b16 v[72:73], v5 offset:8192
    ds_read_b64_tr_b16 v[74:75], v5 offset:9216
    ds_read_b64_tr_b16 v[76:77], v5 offset:16384
    ds_read_b64_tr_b16 v[78:79], v5 offset:17408
    ds_read_b64_tr_b16 v[80:81], v5 offset:24576
    ds_read_b64_tr_b16 v[82:83], v5 offset:25600
    v_cvt_pk_bf16_f32 v124, v100, v101
    v_cvt_pk_bf16_f32 v125, v102, v103
    v_cvt_pk_bf16_f32 v126, v104, v105
    ds_read_b64_tr_b16 v[36:37], v25 offset:32768
    v_cvt_pk_bf16_f32 v127, v106, v107
    v_lshlrev_b32 v108, 16, v124
    v_and_b32 v109, 0xffff0000, v124
    ds_read_b64_tr_b16 v[38:39], v25 offset:33792
    v_lshlrev_b32 v110, 16, v125
    v_and_b32 v111, 0xffff0000, v125
    v_lshlrev_b32 v112, 16, v126
    ds_read_b64_tr_b16 v[40:41], v25 offset:40960
    v_and_b32 v113, 0xffff0000, v126
    v_lshlrev_b32 v114, 16, v127
    v_and_b32 v115, 0xffff0000, v127
    ds_read_b64_tr_b16 v[42:43], v25 offset:41984
    v_mul_f32 v116, 0xbfb8aa3b, v108
    v_mul_f32 v117, 0xbfb8aa3b, v109
    v_mul_f32 v118, 0xbfb8aa3b, v110
    ds_read_b64_tr_b16 v[44:45], v25 offset:49152
    v_mul_f32 v119, 0xbfb8aa3b, v111
    v_mul_f32 v120, 0xbfb8aa3b, v112
    v_mul_f32 v121, 0xbfb8aa3b, v113
    ds_read_b64_tr_b16 v[46:47], v25 offset:50176
    v_mul_f32 v122, 0xbfb8aa3b, v114
    v_mul_f32 v123, 0xbfb8aa3b, v115
    v_exp_f32 v116, v116
    ds_read_b64_tr_b16 v[48:49], v25 offset:57344
    v_exp_f32 v117, v117
    v_exp_f32 v118, v118
    v_exp_f32 v119, v119
    ds_read_b64_tr_b16 v[50:51], v25 offset:58368
    v_exp_f32 v120, v120
    v_exp_f32 v121, v121
    v_exp_f32 v122, v122
    ds_read_b64_tr_b16 v[52:53], v26 offset:32768
    v_exp_f32 v123, v123
    v_add_f32 v116, 1.0, v116
    v_add_f32 v117, 1.0, v117
    ds_read_b64_tr_b16 v[54:55], v26 offset:33792
    v_add_f32 v118, 1.0, v118
    v_add_f32 v119, 1.0, v119
    v_add_f32 v120, 1.0, v120
    ds_read_b64_tr_b16 v[56:57], v26 offset:40960
    v_add_f32 v121, 1.0, v121
    v_add_f32 v122, 1.0, v122
    v_add_f32 v123, 1.0, v123
    ds_read_b64_tr_b16 v[58:59], v26 offset:41984
    v_rcp_f32 v116, v116
    v_rcp_f32 v117, v117
    v_rcp_f32 v118, v118
    ds_read_b64_tr_b16 v[60:61], v26 offset:49152
    v_rcp_f32 v119, v119
    v_rcp_f32 v120, v120
    v_rcp_f32 v121, v121
    ds_read_b64_tr_b16 v[62:63], v26 offset:50176
    v_rcp_f32 v122, v122
    v_rcp_f32 v123, v123
    v_mul_f32 v108, v108, v116
    ds_read_b64_tr_b16 v[64:65], v26 offset:57344
    v_mul_f32 v109, v109, v117
    v_mul_f32 v110, v110, v118
    v_mul_f32 v111, v111, v119
    ds_read_b64_tr_b16 v[66:67], v26 offset:58368
    v_mul_f32 v112, v112, v120
    v_mul_f32 v113, v113, v121
    v_mul_f32 v114, v114, v122
    v_mul_f32 v115, v115, v123
    v_cvt_pk_bf16_f32 v124, v108, v109
    v_cvt_pk_bf16_f32 v125, v110, v111
    v_cvt_pk_bf16_f32 v126, v112, v113
    v_cvt_pk_bf16_f32 v127, v114, v115
    ds_write_b64 v9, v[124:125]
    ds_write_b64 v10, v[126:127]
    s_mov_b64 exec, 1
    ds_add_u32 v35, v32 offset:0
    s_mov_b64 exec, -1
L_gsa:
    ds_read_b32 v34, v35 offset:0
    s_waitcnt lgkmcnt(0)
    v_readfirstlane_b32 s48, v34
    s_nop 0
    s_cmp_lt_u32 s48, 4
    s_cbranch_scc1 L_gsa
    ds_read_b128 v[84:87], v28
    ds_read_b128 v[88:91], v29
    ds_read_b128 v[92:95], v30
    ds_read_b128 v[96:99], v31
    s_mov_b64 exec, 1
    ds_add_u32 v35, v32 offset:4
    s_mov_b64 exec, -1
    s_waitcnt lgkmcnt(4)
    v_mfma_f32_16x16x32_bf16 v[100:103], v[36:39], v[84:87], 0
    s_waitcnt lgkmcnt(3)
    v_mfma_f32_16x16x32_bf16 v[100:103], v[40:43], v[88:91], v[100:103]
    s_waitcnt lgkmcnt(2)
    v_mfma_f32_16x16x32_bf16 v[100:103], v[44:47], v[92:95], v[100:103]
    s_waitcnt lgkmcnt(1)
    v_mfma_f32_16x16x32_bf16 v[100:103], v[48:51], v[96:99], v[100:103]
    ds_read_b64_tr_b16 v[36:37], v6 offset:0
    ds_read_b64_tr_b16 v[38:39], v6 offset:1024
    ds_read_b64_tr_b16 v[40:41], v6 offset:8192
    ds_read_b64_tr_b16 v[42:43], v6 offset:9216
    ds_read_b64_tr_b16 v[44:45], v6 offset:16384
    ds_read_b64_tr_b16 v[46:47], v6 offset:17408
    ds_read_b64_tr_b16 v[48:49], v6 offset:24576
    ds_read_b64_tr_b16 v[50:51], v6 offset:25600
    v_mfma_f32_16x16x32_bf16 v[104:107], v[52:55], v[84:87], 0
    v_mfma_f32_16x16x32_bf16 v[104:107], v[56:59], v[88:91], v[104:107]
    v_mfma_f32_16x16x32_bf16 v[104:107], v[60:63], v[92:95], v[104:107]
    v_mfma_f32_16x16x32_bf16 v[104:107], v[64:67], v[96:99], v[104:107]
    ds_read_b64_tr_b16 v[52:53], v5 offset:32768
    ds_read_b64_tr_b16 v[54:55], v5 offset:33792
    ds_read_b64_tr_b16 v[56:57], v5 offset:40960
    ds_read_b64_tr_b16 v[58:59], v5 offset:41984
    ds_read_b64_tr_b16 v[60:61], v5 offset:49152
    ds_read_b64_tr_b16 v[62:63], v5 offset:50176
    v_mfma_f32_16x16x32_bf16 v[108:111], v[68:71], v[84:87], 0
    v_mfma_f32_16x16x32_bf16 v[108:111], v[72:75], v[88:91], v[108:111]
    v_mfma_f32_16x16x32_bf16 v[108:111], v[76:79], v[92:95], v[108:111]
    v_mfma_f32_16x16x32_bf16 v[108:111], v[80:83], v[96:99], v[108:111]
    ds_read_b64_tr_b16 v[64:65], v5 offset:57344
    ds_read_b64_tr_b16 v[66:67], v5 offset:58368
    v_cvt_pk_bf16_f32 v124, v100, v101
    v_cvt_pk_bf16_f32 v125, v102, v103
    ds_write_b64 v27, v[124:125] offset:0
    s_waitcnt lgkmcnt(9)
    ds_read_b64_tr_b16 v[68:69], v6 offset:32768
    ds_read_b64_tr_b16 v[70:71], v6 offset:33792
    ds_read_b64_tr_b16 v[72:73], v6 offset:40960
    ds_read_b64_tr_b16 v[74:75], v6 offset:41984
    v_mfma_f32_16x16x32_bf16 v[112:115], v[36:39], v[84:87], 0
    v_mfma_f32_16x16x32_bf16 v[112:115], v[40:43], v[88:91], v[112:115]
    v_mfma_f32_16x16x32_bf16 v[112:115], v[44:47], v[92:95], v[112:115]
    v_mfma_f32_16x16x32_bf16 v[112:115], v[48:51], v[96:99], v[112:115]
    ds_read_b64_tr_b16 v[76:77], v6 offset:49152
    ds_read_b64_tr_b16 v[78:79], v6 offset:50176
    ds_read_b64_tr_b16 v[80:81], v6 offset:57344
    ds_read_b64_tr_b16 v[82:83], v6 offset:58368
    v_mov_b32 v11, 163776
    s_mov_b64 exec, 1
    ds_add_u32 v11, v32 offset:4
    s_mov_b64 exec, -1
    v_cvt_pk_bf16_f32 v126, v104, v105
    v_cvt_pk_bf16_f32 v127, v106, v107
    ds_write_b64 v8, v[126:127] offset:0
    s_waitcnt lgkmcnt(10)
    v_mfma_f32_16x16x32_bf16 v[116:119], v[52:55], v[84:87], 0
    v_mfma_f32_16x16x32_bf16 v[116:119], v[56:59], v[88:91], v[116:119]
    v_mfma_f32_16x16x32_bf16 v[116:119], v[60:63], v[92:95], v[116:119]
    v_mfma_f32_16x16x32_bf16 v[116:119], v[64:67], v[96:99], v[116:119]
    v_cvt_pk_bf16_f32 v124, v108, v109
    v_cvt_pk_bf16_f32 v125, v110, v111
    ds_write_b64 v27, v[124:125] offset:16384
    s_waitcnt lgkmcnt(2)
    v_mfma_f32_16x16x32_bf16 v[120:123], v[68:71], v[84:87], 0
    v_mfma_f32_16x16x32_bf16 v[120:123], v[72:75], v[88:91], v[120:123]
    v_mfma_f32_16x16x32_bf16 v[120:123], v[76:79], v[92:95], v[120:123]
    v_mfma_f32_16x16x32_bf16 v[120:123], v[80:83], v[96:99], v[120:123]
    v_cvt_pk_bf16_f32 v126, v112, v113
    v_cvt_pk_bf16_f32 v127, v114, v115
    ds_write_b64 v8, v[126:127] offset:16384
L_gsb:
    ds_read_b32 v34, v35 offset:4
    s_waitcnt lgkmcnt(0)
    v_readfirstlane_b32 s48, v34
    s_nop 0
    s_cmp_lt_u32 s48, 4
    s_cbranch_scc1 L_gsb
    v_cvt_pk_bf16_f32 v124, v116, v117
    v_cvt_pk_bf16_f32 v125, v118, v119
    ds_write_b64 v9, v[124:125]
    v_cvt_pk_bf16_f32 v126, v120, v121
    v_cvt_pk_bf16_f32 v127, v122, v123
    ds_write_b64 v10, v[126:127]
    s_mov_b64 exec, 1
    ds_add_u32 v35, v32 offset:8
    s_mov_b64 exec, -1
    v_lshrrev_b32 v5, 3, v3
    s_mov_b32 s48, 1280000
    v_mul_lo_u32 v5, v5, s48
    v_and_b32 v6, 7, v3
    v_lshl_add_u32 v5, v6, 4, v5
    v_lshl_add_u32 v5, v33, 7, v5
    v_add_u32 v5, 10240000, v5
    v_lshrrev_b32 v6, 2, v3
    s_mov_b32 s48, 2560000
    v_mul_lo_u32 v6, v6, s48
    v_and_b32 v34, 3, v3
    v_lshl_add_u32 v6, v34, 4, v6
    v_lshl_add_u32 v6, v33, 8, v6
    s_movk_i32 s48, 10000
    v_cmp_gt_u32 vcc, s48, v33
L_gsc:
    ds_read_b32 v34, v35 offset:8
    s_waitcnt lgkmcnt(0)
    v_readfirstlane_b32 s48, v34
    s_nop 0
    s_cmp_lt_u32 s48, 4
    s_cbranch_scc1 L_gsc
    s_and_saveexec_b64 s[50:51], vcc
    s_cbranch_execz L_fuse
    ds_read_b128 v[36:39], v7
    ds_read_b128 v[40:43], v7 offset:16384
    ds_read_b128 v[44:47], v24
    s_mov_b32 s52, 0x07060100
    s_mov_b32 s53, 0x07060302
    s_mov_b32 s54, 0x7fff7fff
    s_waitcnt lgkmcnt(2)
    v_lshlrev_b64 v[48:49], 16, v[36:37]
    v_lshlrev_b64 v[50:51], 16, v[38:39]
    v_pk_lshrrev_b16 v48, 15, v48 op_sel_hi:[0,1]
    v_pk_lshrrev_b16 v49, 15, v49 op_sel_hi:[0,1]
    v_pk_lshrrev_b16 v50, 15, v50 op_sel_hi:[0,1]
    v_pk_lshrrev_b16 v51, 15, v51 op_sel_hi:[0,1]
    v_and_b32 v52, 0x7fff7fff, v36
    v_and_b32 v53, 0x7fff7fff, v37
    v_and_b32 v54, 0x7fff7fff, v38
    v_and_b32 v55, 0x7fff7fff, v39
    v_pk_sub_u16 v52, v52, v48 clamp
    v_pk_sub_u16 v53, v53, v49 clamp
    v_pk_sub_u16 v54, v54, v50 clamp
    v_pk_sub_u16 v55, v55, v51 clamp
    v_bfi_b32 v36, s54, v52, v36
    v_bfi_b32 v37, s54, v53, v37
    v_bfi_b32 v38, s54, v54, v38
    v_bfi_b32 v39, s54, v55, v39
    s_cmp_lt_u32 s41, 4
    buffer_store_dwordx4 v[36:39], v5, s[36:39], 0 offen sc1
    s_waitcnt vmcnt(1) lgkmcnt(0)
    v_lshlrev_b32 v64, 16, v40
    v_and_b32 v65, 0xffff0000, v40
    v_lshlrev_b32 v68, 16, v12
    v_and_b32 v69, 0xffff0000, v12
    v_lshlrev_b32 v70, 16, v16
    v_and_b32 v71, 0xffff0000, v16
    v_lshlrev_b32 v72, 16, v20
    v_and_b32 v73, 0xffff0000, v20
    v_mul_f32 v68, v64, v68
    v_mul_f32 v69, v65, v69
    v_mul_f32 v70, v64, v70
    v_mul_f32 v71, v65, v71
    v_mul_f32 v72, v64, v72
    v_mul_f32 v73, v65, v73
    v_perm_b32 v48, v70, v44, s52
    v_perm_b32 v49, v72, v68, s53
    v_perm_b32 v50, v71, v44, s53
    v_perm_b32 v51, v73, v69, s53
    buffer_store_dwordx4 v[48:51], v6, s[36:39], 0 offen offset:0 sc1
    v_lshlrev_b32 v64, 16, v41
    v_and_b32 v65, 0xffff0000, v41
    v_lshlrev_b32 v68, 16, v13
    v_and_b32 v69, 0xffff0000, v13
    v_lshlrev_b32 v70, 16, v17
    v_and_b32 v71, 0xffff0000, v17
    v_lshlrev_b32 v72, 16, v21
    v_and_b32 v73, 0xffff0000, v21
    v_mul_f32 v68, v64, v68
    v_mul_f32 v69, v65, v69
    v_mul_f32 v70, v64, v70
    v_mul_f32 v71, v65, v71
    v_mul_f32 v72, v64, v72
    v_mul_f32 v73, v65, v73
    v_perm_b32 v52, v70, v45, s52
    v_perm_b32 v53, v72, v68, s53
    v_perm_b32 v54, v71, v45, s53
    v_perm_b32 v55, v73, v69, s53
    buffer_store_dwordx4 v[52:55], v6, s[36:39], 0 offen offset:64 sc1
    v_lshlrev_b32 v64, 16, v42
    v_and_b32 v65, 0xffff0000, v42
    v_lshlrev_b32 v68, 16, v14
    v_and_b32 v69, 0xffff0000, v14
    v_lshlrev_b32 v70, 16, v18
    v_and_b32 v71, 0xffff0000, v18
    v_lshlrev_b32 v72, 16, v22
    v_and_b32 v73, 0xffff0000, v22
    v_mul_f32 v68, v64, v68
    v_mul_f32 v69, v65, v69
    v_mul_f32 v70, v64, v70
    v_mul_f32 v71, v65, v71
    v_mul_f32 v72, v64, v72
    v_mul_f32 v73, v65, v73
    v_perm_b32 v56, v70, v46, s52
    v_perm_b32 v57, v72, v68, s53
    v_perm_b32 v58, v71, v46, s53
    v_perm_b32 v59, v73, v69, s53
    buffer_store_dwordx4 v[56:59], v6, s[36:39], 0 offen offset:128 sc1
    v_lshlrev_b32 v64, 16, v43
    v_and_b32 v65, 0xffff0000, v43
    v_lshlrev_b32 v68, 16, v15
    v_and_b32 v69, 0xffff0000, v15
    v_lshlrev_b32 v70, 16, v19
    v_and_b32 v71, 0xffff0000, v19
    v_lshlrev_b32 v72, 16, v23
    v_and_b32 v73, 0xffff0000, v23
    v_mul_f32 v68, v64, v68
    v_mul_f32 v69, v65, v69
    v_mul_f32 v70, v64, v70
    v_mul_f32 v71, v65, v71
    v_mul_f32 v72, v64, v72
    v_mul_f32 v73, v65, v73
    v_perm_b32 v60, v70, v47, s52
    v_perm_b32 v61, v72, v68, s53
    v_perm_b32 v62, v71, v47, s53
    v_perm_b32 v63, v73, v69, s53
    buffer_store_dwordx4 v[60:63], v6, s[36:39], 0 offen offset:192 sc1
    s_branch L_fuse
L_k1_other:
    s_cmp_ge_u32 s2, 237
    s_cbranch_scc1 L_k1_misc
    s_sub_u32 s23, s2, 157
    s_mul_i32 s48, s23, 16000
    v_lshlrev_b32 v2, 4, v0
    v_add_u32 v3, s48, v2
    v_mul_u32_u24 v12, 12, v0
    v_add_u32 v52, 0x3000, v12
    v_add_u32 v53, 0x6000, v12
    v_add_u32 v54, 0x9000, v12
    v_add_u32 v55, 0xc000, v12
    s_mul_i32 s50, s23, 57344
    s_add_u32 s50, s50, 12902400
    s_movk_i32 s51, 1000
    v_cmp_gt_u32 s[44:45], s51, v0
    v_lshlrev_b32 v13, 2, v1
    v_add_u32 v13, 81920, v13
    v_mov_b32 v14, 0
    ds_write_b32 v13, v14
    s_waitcnt lgkmcnt(0)
    s_mov_b32 s24, s6
    s_mov_b32 s25, s7
    s_mov_b32 s26, 60000
    s_mov_b32 s27, 0x00020000
    s_mov_b32 s28, s8
    s_mov_b32 s29, s9
    s_mov_b32 s30, 1280000
    s_mov_b32 s31, 0x00020000
    s_mov_b32 s32, s10
    s_mov_b32 s33, s11
    s_mov_b32 s34, 1280000
    s_mov_b32 s35, 0x00020000
    s_add_u32 s36, s20, s50
    s_addc_u32 s37, s21, 0
    s_mov_b32 s38, 57344
    s_mov_b32 s39, 0x00020000
    s_add_u32 s40, s20, 12881920
    s_addc_u32 s41, s21, 0
    s_mov_b32 s42, 20480
    s_mov_b32 s43, 0x00020000
    buffer_load_dwordx4 v[4:7], v3, s[28:31], 0 offen
    buffer_load_dwordx4 v[8:11], v3, s[32:35], 0 offen
    buffer_load_dwordx3 v[32:34], v12, s[24:27], 0 offen
    buffer_load_dwordx3 v[36:38], v52, s[24:27], 0 offen
    buffer_load_dwordx3 v[40:42], v53, s[24:27], 0 offen
    buffer_load_dwordx3 v[44:46], v54, s[24:27], 0 offen
    buffer_load_dwordx3 v[48:50], v55, s[24:27], 0 offen
    s_mov_b32 s52, 0x409c0000
    s_mov_b32 s53, 0x07060100
    s_mov_b32 s54, 0x07060302
    s_movk_i32 s55, -157
    v_mov_b32 v15, 1
    s_mov_b32 s46, 82944
    v_add_u32 v108, 0, v0
    v_mul_u32_u24 v100, 2341, v108
    v_lshrrev_b32 v100, 17, v100
    v_mul_u32_u24 v109, 56, v100
    v_sub_u32 v104, v108, v109
    v_lshlrev_b32 v104, 4, v104
    v_mul_u32_u24 v118, 912, v100
    v_add3_u32 v118, v118, v104, s46
    v_lshlrev_b32 v100, 2, v100
    v_add_u32 v100, 81920, v100
    v_add_u32 v108, 1024, v0
    v_mul_u32_u24 v101, 2341, v108
    v_lshrrev_b32 v101, 17, v101
    v_mul_u32_u24 v109, 56, v101
    v_sub_u32 v105, v108, v109
    v_lshlrev_b32 v105, 4, v105
    v_mul_u32_u24 v119, 912, v101
    v_add3_u32 v119, v119, v105, s46
    v_lshlrev_b32 v101, 2, v101
    v_add_u32 v101, 81920, v101
    v_add_u32 v108, 2048, v0
    v_mul_u32_u24 v102, 2341, v108
    v_lshrrev_b32 v102, 17, v102
    v_mul_u32_u24 v109, 56, v102
    v_sub_u32 v106, v108, v109
    v_lshlrev_b32 v106, 4, v106
    v_mul_u32_u24 v120, 912, v102
    v_add3_u32 v120, v120, v106, s46
    v_lshlrev_b32 v102, 2, v102
    v_add_u32 v102, 81920, v102
    v_add_u32 v108, 3072, v0
    v_mul_u32_u24 v103, 2341, v108
    v_lshrrev_b32 v103, 17, v103
    v_mul_u32_u24 v109, 56, v103
    v_sub_u32 v107, v108, v109
    v_lshlrev_b32 v107, 4, v107
    v_mul_u32_u24 v121, 912, v103
    v_add3_u32 v121, v121, v107, s46
    v_lshlrev_b32 v103, 2, v103
    v_add_u32 v103, 81920, v103
    v_add_u32 v109, 0x4000, v2
    v_add_u32 v110, 0x8000, v2
    v_add_u32 v111, 0xc000, v2
    v_mul_u32_u24 v112, 224, v1
    v_or_b32 v112, 0x80000000, v112
    v_add_u32 v108, 0x10000, v2
    s_waitcnt vmcnt(5)
    v_lshlrev_b32 v16, 3, v4
    v_lshlrev_b32 v20, 3, v8
    v_mul_u32_u24 v24, 6679, v8
    v_lshrrev_b32 v24, 20, v24
    v_mad_i32_i24 v28, v24, s55, v8
    v_lshl_or_b32 v28, v4, 8, v28
    v_lshlrev_b32 v24, 2, v24
    v_mul_u32_u24 v76, 228, v24
    v_add_u32 v76, 82944, v76
    v_lshlrev_b32 v17, 3, v5
    v_lshlrev_b32 v21, 3, v9
    v_mul_u32_u24 v25, 6679, v9
    v_lshrrev_b32 v25, 20, v25
    v_mad_i32_i24 v29, v25, s55, v9
    v_lshl_or_b32 v29, v5, 8, v29
    v_lshlrev_b32 v25, 2, v25
    v_mul_u32_u24 v77, 228, v25
    v_add_u32 v77, 82944, v77
    v_lshlrev_b32 v18, 3, v6
    v_lshlrev_b32 v22, 3, v10
    v_mul_u32_u24 v26, 6679, v10
    v_lshrrev_b32 v26, 20, v26
    v_mad_i32_i24 v30, v26, s55, v10
    v_lshl_or_b32 v30, v6, 8, v30
    v_lshlrev_b32 v26, 2, v26
    v_mul_u32_u24 v78, 228, v26
    v_add_u32 v78, 82944, v78
    v_lshlrev_b32 v19, 3, v7
    v_lshlrev_b32 v23, 3, v11
    v_mul_u32_u24 v27, 6679, v11
    v_lshrrev_b32 v27, 20, v27
    v_mad_i32_i24 v31, v27, s55, v11
    v_lshl_or_b32 v31, v7, 8, v31
    v_lshlrev_b32 v27, 2, v27
    v_mul_u32_u24 v79, 228, v27
    v_add_u32 v79, 82944, v79
    s_waitcnt vmcnt(4)
    v_and_b32 v35, 0xffff0000, v34
    v_alignbit_b32 v34, v34, v33, 16
    v_lshlrev_b32 v33, 16, v33
    ds_write_b128 v2, v[32:35] offset:0
    s_waitcnt vmcnt(3)
    v_and_b32 v39, 0xffff0000, v38
    v_alignbit_b32 v38, v38, v37, 16
    v_lshlrev_b32 v37, 16, v37
    ds_write_b128 v2, v[36:39] offset:16384
    s_waitcnt vmcnt(2)
    v_and_b32 v43, 0xffff0000, v42
    v_alignbit_b32 v42, v42, v41, 16
    v_lshlrev_b32 v41, 16, v41
    ds_write_b128 v2, v[40:43] offset:32768
    s_waitcnt vmcnt(1)
    v_and_b32 v47, 0xffff0000, v46
    v_alignbit_b32 v46, v46, v45, 16
    v_lshlrev_b32 v45, 16, v45
    ds_write_b128 v2, v[44:47] offset:49152
    s_waitcnt vmcnt(0)
    v_and_b32 v51, 0xffff0000, v50
    v_alignbit_b32 v50, v50, v49, 16
    v_lshlrev_b32 v49, 16, v49
    ds_write_b128 v108, v[48:51] offset:0
    s_waitcnt lgkmcnt(0)
    s_barrier

    s_mov_b64 exec, -1
    s_cmp_ge_u32 s22, 10
    s_cbranch_scc1 L_rle
    s_mov_b32 s64, s4
    s_mov_b32 s65, s5
    s_mov_b32 s66, 10240000
    s_mov_b32 s67, 0x00020000
    s_and_b32 s40, s2, 1
    s_lshl_b32 s40, s40, 5
    s_lshr_b32 s41, s2, 3
    s_add_u32 s40, s40, s41
    s_mul_i32 s40, s40, 160768
    s_lshl_b32 s41, s22, 14
    s_add_u32 s40, s40, s41
    s_bfe_u32 s41, s2, 0x20001
    s_lshl_b32 s42, s41, 6
    s_add_u32 s42, s42, s40
    v_lshrrev_b32 v116, 2, v1
    v_lshlrev_b32 v116, 10, v116
    v_and_b32 v117, 3, v1
    v_lshl_add_u32 v116, v117, 4, v116
    v_add_u32 v116, s42, v116
    buffer_load_dwordx4 v[82:85], v116, s[64:67], 0 offen offset:256
    buffer_load_dwordx4 v[86:89], v116, s[64:67], 0 offen offset:512
    buffer_load_dwordx4 v[90:93], v116, s[64:67], 0 offen offset:768
    s_lshr_b32 s42, s41, 1
    s_lshl_b32 s42, s42, 10
    s_add_u32 s40, s40, s42
    s_and_b32 s42, s41, 1
    s_lshl_b32 s42, s42, 7
    s_add_u32 s40, s40, s42
    v_lshrrev_b32 v116, 3, v1
    v_lshlrev_b32 v116, 11, v116
    v_and_b32 v117, 7, v1
    v_lshl_add_u32 v116, v117, 4, v116
    v_add_u32 v116, s40, v116
    buffer_load_dwordx4 v[94:97], v116, s[64:67], 0 offen
L_rle:
    ds_read_b64 v[4:5], v16
    ds_read_b64 v[122:123], v20
    ds_read_b64 v[6:7], v17
    ds_read_b64 v[124:125], v21
    ds_read_b64 v[8:9], v18
    ds_read_b64 v[126:127], v22
    ds_read_b64 v[10:11], v19
    ds_read_b64 v[98:99], v23
    s_waitcnt lgkmcnt(4)
    v_lshlrev_b32 v32, 16, v4
    v_lshlrev_b32 v44, 16, v122
    v_and_b32 v33, 0xffff0000, v4
    v_and_b32 v45, 0xffff0000, v122
    v_sub_f32 v34, v5, v123
    v_sub_f32 v32, v32, v44
    v_sub_f32 v33, v33, v45
    v_lshlrev_b32 v35, 16, v6
    v_lshlrev_b32 v47, 16, v124
    v_and_b32 v36, 0xffff0000, v6
    v_and_b32 v48, 0xffff0000, v124
    v_sub_f32 v37, v7, v125
    v_sub_f32 v35, v35, v47
    v_sub_f32 v36, v36, v48
    v_cvt_pk_bf16_f32 v68, v32, v33
    v_cvt_pk_bf16_f32 v69, v34, v35
    v_cvt_pk_bf16_f32 v70, v36, v37
    v_lshlrev_b32 v32, 16, v68
    v_and_b32 v33, 0xffff0000, v68
    v_lshlrev_b32 v34, 16, v69
    v_and_b32 v35, 0xffff0000, v69
    v_lshlrev_b32 v36, 16, v70
    v_and_b32 v37, 0xffff0000, v70
    v_mul_f32 v44, v32, v32
    v_mul_f32 v45, v33, v33
    v_mul_f32 v46, v34, v34
    v_mul_f32 v47, v35, v35
    v_mul_f32 v48, v36, v36
    v_mul_f32 v49, v37, v37
    v_cvt_pk_bf16_f32 v68, v44, v45
    v_cvt_pk_bf16_f32 v69, v46, v47
    v_cvt_pk_bf16_f32 v70, v48, v49
    v_lshlrev_b32 v44, 16, v68
    v_and_b32 v45, 0xffff0000, v68
    v_lshlrev_b32 v46, 16, v69
    v_and_b32 v47, 0xffff0000, v69
    v_lshlrev_b32 v48, 16, v70
    v_and_b32 v49, 0xffff0000, v70
    v_add_f32 v44, v44, v45
    v_add_f32 v47, v47, v48
    v_add_f32 v44, v44, v46
    v_add_f32 v45, v47, v49
    v_cvt_pk_bf16_f32 v68, v44, v45
    v_lshlrev_b32 v44, 16, v68
    v_and_b32 v45, 0xffff0000, v68
    v_add_f32 v44, 0x322bcc77, v44
    v_add_f32 v45, 0x322bcc77, v45
    v_cvt_pk_bf16_f32 v68, v44, v45
    v_lshlrev_b32 v44, 16, v68
    v_and_b32 v45, 0xffff0000, v68
    v_sqrt_f32 v44, v44
    v_sqrt_f32 v45, v45
    s_nop 0
    v_cvt_pk_bf16_f32 v68, v44, v45
    v_lshlrev_b32 v44, 16, v68
    v_and_b32 v45, 0xffff0000, v68
    v_rcp_f32 v46, v44
    v_rcp_f32 v47, v45
    v_cmp_ge_u32 s[56:57], s52, v44
    v_subrev_u32 v48, 0x38d10000, v44
    v_lshlrev_b32 v48, 5, v48
    v_cmp_ge_u32 s[58:59], s52, v45
    v_subrev_u32 v49, 0x38d10000, v45
    v_lshlrev_b32 v49, 5, v49
    v_mul_f32 v32, v32, v46
    v_mul_f32 v33, v33, v46
    v_mul_f32 v34, v34, v46
    v_mul_f32 v35, v35, v47
    v_mul_f32 v36, v36, v47
    v_mul_f32 v37, v37, v47
    v_cvt_pk_bf16_f32 v56, v32, v33
    v_cvt_pk_bf16_f32 v57, v35, v36
    v_cvt_pk_bf16_f32 v68, v34, v37
    v_perm_b32 v60, v48, v68, s53
    v_perm_b32 v61, v49, v68, s54
    s_and_b64 s[56:57], s[56:57], s[44:45]
    s_mov_b64 exec, s[56:57]
    v_add_u32 v69, 81920, v24
    ds_add_rtn_u32 v64, v69, v15
    s_and_b64 s[58:59], s[58:59], s[44:45]
    s_mov_b64 exec, s[58:59]
    v_add_u32 v70, 81920, v25
    ds_add_rtn_u32 v65, v70, v15
    s_mov_b64 exec, -1
    s_waitcnt lgkmcnt(2)
    v_lshlrev_b32 v38, 16, v8
    v_lshlrev_b32 v50, 16, v126
    v_and_b32 v39, 0xffff0000, v8
    v_and_b32 v51, 0xffff0000, v126
    v_sub_f32 v40, v9, v127
    v_sub_f32 v38, v38, v50
    v_sub_f32 v39, v39, v51
    v_lshlrev_b32 v41, 16, v10
    v_lshlrev_b32 v53, 16, v98
    v_and_b32 v42, 0xffff0000, v10
    v_and_b32 v54, 0xffff0000, v98
    v_sub_f32 v43, v11, v99
    v_sub_f32 v41, v41, v53
    v_sub_f32 v42, v42, v54
    v_cvt_pk_bf16_f32 v68, v38, v39
    v_cvt_pk_bf16_f32 v69, v40, v41
    v_cvt_pk_bf16_f32 v70, v42, v43
    v_lshlrev_b32 v38, 16, v68
    v_and_b32 v39, 0xffff0000, v68
    v_lshlrev_b32 v40, 16, v69
    v_and_b32 v41, 0xffff0000, v69
    v_lshlrev_b32 v42, 16, v70
    v_and_b32 v43, 0xffff0000, v70
    v_mul_f32 v50, v38, v38
    v_mul_f32 v51, v39, v39
    v_mul_f32 v52, v40, v40
    v_mul_f32 v53, v41, v41
    v_mul_f32 v54, v42, v42
    v_mul_f32 v55, v43, v43
    v_cvt_pk_bf16_f32 v68, v50, v51
    v_cvt_pk_bf16_f32 v69, v52, v53
    v_cvt_pk_bf16_f32 v70, v54, v55
    v_lshlrev_b32 v50, 16, v68
    v_and_b32 v51, 0xffff0000, v68
    v_lshlrev_b32 v52, 16, v69
    v_and_b32 v53, 0xffff0000, v69
    v_lshlrev_b32 v54, 16, v70
    v_and_b32 v55, 0xffff0000, v70
    v_add_f32 v50, v50, v51
    v_add_f32 v53, v53, v54
    v_add_f32 v50, v50, v52
    v_add_f32 v51, v53, v55
    v_cvt_pk_bf16_f32 v68, v50, v51
    v_lshlrev_b32 v50, 16, v68
    v_and_b32 v51, 0xffff0000, v68
    v_add_f32 v50, 0x322bcc77, v50
    v_add_f32 v51, 0x322bcc77, v51
    v_cvt_pk_bf16_f32 v68, v50, v51
    v_lshlrev_b32 v50, 16, v68
    v_and_b32 v51, 0xffff0000, v68
    v_sqrt_f32 v50, v50
    v_sqrt_f32 v51, v51
    s_nop 0
    v_cvt_pk_bf16_f32 v68, v50, v51
    v_lshlrev_b32 v50, 16, v68
    v_and_b32 v51, 0xffff0000, v68
    v_rcp_f32 v52, v50
    v_rcp_f32 v53, v51
    v_cmp_ge_u32 s[60:61], s52, v50
    v_subrev_u32 v54, 0x38d10000, v50
    v_lshlrev_b32 v54, 5, v54
    v_cmp_ge_u32 s[62:63], s52, v51
    v_subrev_u32 v55, 0x38d10000, v51
    v_lshlrev_b32 v55, 5, v55
    v_mul_f32 v38, v38, v52
    v_mul_f32 v39, v39, v52
    v_mul_f32 v40, v40, v52
    v_mul_f32 v41, v41, v53
    v_mul_f32 v42, v42, v53
    v_mul_f32 v43, v43, v53
    v_cvt_pk_bf16_f32 v58, v38, v39
    v_cvt_pk_bf16_f32 v59, v41, v42
    v_cvt_pk_bf16_f32 v68, v40, v43
    v_perm_b32 v62, v54, v68, s53
    v_perm_b32 v63, v55, v68, s54
    s_and_b64 s[60:61], s[60:61], s[44:45]
    s_mov_b64 exec, s[60:61]
    v_add_u32 v69, 81920, v26
    ds_add_rtn_u32 v66, v69, v15
    s_and_b64 s[62:63], s[62:63], s[44:45]
    s_mov_b64 exec, s[62:63]
    v_add_u32 v70, 81920, v27
    ds_add_rtn_u32 v67, v70, v15
    s_mov_b64 exec, -1
    s_cmp_lg_u32 s22, 0
    s_cbranch_scc1 L_k1_nrc
    v_mov_b32 v74, 0
    buffer_load_dword v73, v74, s[76:79], 0 offen sc1
L_k1_nrc:
    s_waitcnt lgkmcnt(3)
    v_cmp_gt_u32 vcc, 74, v64
    v_mad_u32_u24 v76, v64, 12, v76
    s_and_b64 exec, vcc, s[56:57]
    ds_write2_b32 v76, v56, v60 offset0:0 offset1:1
    ds_write_b32 v76, v28 offset:8
    s_mov_b64 exec, -1
    s_waitcnt lgkmcnt(4)
    v_cmp_gt_u32 vcc, 74, v65
    v_mad_u32_u24 v77, v65, 12, v77
    s_and_b64 exec, vcc, s[58:59]
    ds_write2_b32 v77, v57, v61 offset0:0 offset1:1
    ds_write_b32 v77, v29 offset:8
    s_mov_b64 exec, -1
    s_waitcnt lgkmcnt(5)
    v_cmp_gt_u32 vcc, 74, v66
    v_mad_u32_u24 v78, v66, 12, v78
    s_and_b64 exec, vcc, s[60:61]
    ds_write2_b32 v78, v58, v62 offset0:0 offset1:1
    ds_write_b32 v78, v30 offset:8
    s_mov_b64 exec, -1
    s_waitcnt lgkmcnt(6)
    v_cmp_gt_u32 vcc, 74, v67
    v_mad_u32_u24 v79, v67, 12, v79
    s_and_b64 exec, vcc, s[62:63]
    ds_write2_b32 v79, v59, v63 offset0:0 offset1:1
    ds_write_b32 v79, v31 offset:8
    s_mov_b64 exec, -1
    s_waitcnt lgkmcnt(0)
    s_barrier
    ds_read_b32 v14, v13
    ds_read_b32 v100, v100
    ds_read_b32 v101, v101
    ds_read_b32 v102, v102
    ds_read_b32 v103, v103
    ds_read_b128 v[4:7], v118
    ds_read_b128 v[8:11], v119
    ds_read_b128 v[32:35], v120
    ds_read_b128 v[36:39], v121
    s_waitcnt lgkmcnt(4)
    v_cmp_lt_u32 vcc, 74, v14
    s_cbranch_vccnz L_k1_slow
    v_lshl_or_b32 v72, v14, 16, v112
    v_mul_u32_u24 v100, 12, v100
    v_cmp_gt_u32 vcc, v100, v104
    s_nop 0
    s_and_b64 exec, vcc, vcc
    s_cbranch_execz L_k1_c0
    s_waitcnt lgkmcnt(3)
    buffer_store_dwordx4 v[4:7], v2, s[36:39], 0 offen sc1
L_k1_c0:
    s_mov_b64 exec, -1
    v_mul_u32_u24 v101, 12, v101
    v_cmp_gt_u32 vcc, v101, v105
    s_nop 0
    s_and_b64 exec, vcc, vcc
    s_cbranch_execz L_k1_c1
    s_waitcnt lgkmcnt(2)
    buffer_store_dwordx4 v[8:11], v109, s[36:39], 0 offen sc1
L_k1_c1:
    s_mov_b64 exec, -1
    v_mul_u32_u24 v102, 12, v102
    v_cmp_gt_u32 vcc, v102, v106
    s_nop 0
    s_and_b64 exec, vcc, vcc
    s_cbranch_execz L_k1_c2
    s_waitcnt lgkmcnt(1)
    buffer_store_dwordx4 v[32:35], v110, s[36:39], 0 offen sc1
L_k1_c2:
    s_mov_b64 exec, -1
    s_cmp_ge_u32 s22, 8
    s_cbranch_scc1 L_k1_e3
    v_mul_u32_u24 v103, 12, v103
    v_cmp_gt_u32 vcc, v103, v107
    s_nop 0
    s_and_b64 exec, vcc, vcc
    s_cbranch_execz L_k1_c3
    s_waitcnt lgkmcnt(0)
    buffer_store_dwordx4 v[36:39], v111, s[36:39], 0 offen sc1
L_k1_c3:
    s_mov_b64 exec, -1
L_k1_e3:
    s_waitcnt lgkmcnt(0)
    s_branch L_k1_e2
L_k1_slow:
    s_waitcnt lgkmcnt(0)
    v_mov_b32 v12, v14
    s_nop 1
    v_add_u32_dpp v12, v12, v12 row_shr:1 row_mask:0xf bank_mask:0xf
    s_nop 1
    v_add_u32_dpp v12, v12, v12 row_shr:2 row_mask:0xf bank_mask:0xf
    s_nop 1
    v_add_u32_dpp v12, v12, v12 row_shr:4 row_mask:0xf bank_mask:0xf
    s_nop 1
    v_add_u32_dpp v12, v12, v12 row_shr:8 row_mask:0xf bank_mask:0xf
    s_nop 1
    v_add_u32_dpp v12, v12, v12 row_bcast:15 row_mask:0xa bank_mask:0xf
    s_nop 1
    v_add_u32_dpp v12, v12, v12 row_bcast:31 row_mask:0xc bank_mask:0xf
    s_nop 0
    v_readlane_b32 s48, v12, 63
    v_sub_u32 v12, v12, v14
    ds_bpermute_b32 v16, v24, v12
    ds_bpermute_b32 v17, v25, v12
    ds_bpermute_b32 v18, v26, v12
    ds_bpermute_b32 v19, v27, v12
    s_mul_i32 s48, s48, 12
    s_add_u32 s48, s48, 15
    s_and_b32 s38, s48, 0xfffffff0
    v_mul_u32_u24 v72, 3, v12
    v_lshl_or_b32 v72, v14, 16, v72
    v_or_b32 v72, 0x80000000, v72
L_k1_noseg:
    s_waitcnt lgkmcnt(0)
    v_add_u32 v16, v16, v64
    v_mul_u32_u24 v16, 12, v16
    v_add_u32 v17, v17, v65
    v_mul_u32_u24 v17, 12, v17
    v_add_u32 v18, v18, v66
    v_mul_u32_u24 v18, 12, v18
    v_add_u32 v19, v19, v67
    v_mul_u32_u24 v19, 12, v19
    s_mov_b64 exec, s[56:57]
    ds_write2_b32 v16, v56, v60 offset0:0 offset1:1
    ds_write_b32 v16, v28 offset:8
    s_mov_b64 exec, s[58:59]
    ds_write2_b32 v17, v57, v61 offset0:0 offset1:1
    ds_write_b32 v17, v29 offset:8
    s_mov_b64 exec, s[60:61]
    ds_write2_b32 v18, v58, v62 offset0:0 offset1:1
    ds_write_b32 v18, v30 offset:8
    s_mov_b64 exec, s[62:63]
    ds_write2_b32 v19, v59, v63 offset0:0 offset1:1
    ds_write_b32 v19, v31 offset:8
    s_mov_b64 exec, -1
    s_waitcnt lgkmcnt(0)
    s_barrier
    ds_read_b128 v[4:7], v2
    ds_read_b128 v[8:11], v2 offset:16384
    ds_read_b128 v[16:19], v2 offset:32768
    v_add_u32 v12, 0x4000, v2
    v_add_u32 v13, 0x8000, v2
    s_lshl_b32 s49, s22, 10
    s_add_u32 s49, s49, 0x8000
    s_waitcnt lgkmcnt(2)
    buffer_store_dwordx4 v[4:7], v2, s[36:39], 0 offen sc1
    s_waitcnt lgkmcnt(1)
    buffer_store_dwordx4 v[8:11], v12, s[36:39], 0 offen sc1
    s_cmp_ge_u32 s49, s38
    s_cbranch_scc1 L_k1_e2
    s_waitcnt lgkmcnt(0)
    buffer_store_dwordx4 v[16:19], v13, s[36:39], 0 offen sc1
L_k1_e2:
    v_mov_b32 v30, v72
    s_branch L_fuse
L_k1_misc:
    s_getpc_b64 s[64:65]
L_pc:
    s_sub_u32 s64, s64, L_pc-standalone__molecular_angular_painn__graph_kernel
    s_subb_u32 s65, s65, 0
    s_mov_b32 s66, L_code_end-standalone__molecular_angular_painn__graph_kernel
    s_mov_b32 s67, 0x00020000
    v_lshlrev_b32 v2, 4, v0
    buffer_load_dwordx4 v[120:123], v2, s[64:67], 0 offen
L_rlm0:
    s_cmp_ge_u32 s2, 253
    s_cbranch_scc1 L_fuse
    s_sub_u32 s65, s2, 237
    v_mov_b32 v4, 0
    v_mov_b32 v5, 0
    v_mov_b32 v6, 0
    v_mov_b32 v7, 0
    s_cmp_lt_u32 s22, 13
    s_cbranch_scc1 L_nors
    s_cmp_eq_u32 s22, 15
    s_cbranch_scc1 L_nors2
    s_lshl_b32 s66, s65, 11
    s_sub_u32 s66, s66, 13312
    v_lshl_add_u32 v2, v0, 4, s66
    buffer_store_dwordx4 v[4:7], v2, s[72:75], 0 offen sc1
    s_branch L_nors
L_nors2:
    s_lshl_b32 s65, s65, 10
    s_add_u32 s65, s65, 32768
    v_lshl_add_u32 v2, v1, 4, s65
    v_mov_b32 v8, 0
    v_cmp_le_u32 vcc, 39, v1
    s_nop 1
    v_cndmask_b32 v9, 0, 1, vcc
    v_mov_b32 v10, v9
    v_mov_b32 v11, v9
    buffer_store_dwordx4 v[8:11], v2, s[72:75], 0 offen sc1
L_nors:
    s_sub_u32 s23, s2, 237
    v_and_b32 v2, 7, v0
    v_lshlrev_b32 v2, 2, v2
    v_lshrrev_b32 v3, 3, v0
    s_lshl_b32 s48, s23, 7
    v_add_u32 v3, s48, v3
    v_add_u32 v4, 0x38d1, v3
    v_lshlrev_b32 v4, 16, v4
    s_waitcnt lgkmcnt(0)
    s_mov_b32 s24, s12
    s_mov_b32 s25, s13
    s_mov_b32 s26, 32
    s_mov_b32 s27, 0x00020000
    s_mov_b32 s28, s18
    s_mov_b32 s29, s19
    s_mov_b32 s30, 12288
    s_mov_b32 s31, 0x00020000
    s_add_u32 s32, s20, 12800000
    s_addc_u32 s33, s21, 0
    s_mov_b32 s34, 81920
    s_mov_b32 s35, 0x00020000
    buffer_load_dword v5, v2, s[24:27], 0 offen
    s_lshr_b32 s40, s22, 1
    v_and_b32 v20, 15, v1
    v_lshrrev_b32 v21, 4, v1
    s_cmp_ge_u32 s40, 4
    s_cbranch_scc1 L_k1_fds
    v_and_b32 v22, 3, v20
    v_lshlrev_b32 v22, 3, v22
    v_lshrrev_b32 v23, 2, v20
    v_lshl_add_u32 v22, v23, 1, v22
    s_lshl_b32 s41, s23, 5
    s_and_b32 s42, s40, 1
    s_add_u32 s41, s41, s42
    s_lshr_b32 s42, s40, 1
    s_lshl_b32 s42, s42, 7
    s_add_u32 s41, s41, s42
    s_add_u32 s41, s41, 128
    s_branch L_k1_fj
L_k1_fds:
    v_and_b32 v22, 7, v20
    v_lshlrev_b32 v22, 3, v22
    v_lshrrev_b32 v23, 3, v20
    v_lshl_add_u32 v22, v23, 2, v22
    s_and_b32 s41, s23, 1
    s_lshl_b32 s41, s41, 6
    s_add_u32 s41, s41, s40
    s_sub_u32 s41, s41, 4
L_k1_fj:
    v_add_lshl_u32 v22, v22, s41, 1
    s_and_b32 s42, s22, 1
    s_mul_i32 s42, s42, 1536
    v_mul_u32_u24 v23, 0xc00, v21
    v_add3_u32 v22, v22, v23, s42
    buffer_load_ushort v24, v22, s[28:31], 0 offen
    buffer_load_ushort v25, v22, s[28:31], 0 offen offset:768
    v_mul_f32 v6, 0x40490fdb, v4
    v_cvt_pk_bf16_f32 v6, v6, v6
    v_lshlrev_b32 v6, 16, v6
    v_mul_f32 v6, 0x3e4ccccd, v6
    v_cvt_pk_bf16_f32 v6, v6, v6
    v_lshlrev_b32 v6, 16, v6
    v_mul_f32 v6, 0.15915494, v6
    v_cos_f32 v6, v6
    s_nop 0
    v_cvt_pk_bf16_f32 v6, v6, v6
    v_lshlrev_b32 v6, 16, v6
    v_add_f32 v6, 1.0, v6
    v_cvt_pk_bf16_f32 v6, v6, v6
    v_lshlrev_b32 v6, 16, v6
    v_mul_f32 v6, 0.5, v6
    v_cmp_ne_u32 vcc, 0, v3
    s_nop 1
    v_cndmask_b32 v6, 0, v6, vcc
    v_rcp_f32 v7, v4
    s_waitcnt vmcnt(2)
    v_lshlrev_b32 v8, 16, v5
    v_and_b32 v9, 0xffff0000, v5
    v_mul_f32 v8, v8, v4
    v_mul_f32 v9, v9, v4
    v_cvt_pk_bf16_f32 v10, v8, v9
    v_lshlrev_b32 v8, 16, v10
    v_and_b32 v9, 0xffff0000, v10
    v_mul_f32 v8, 0.15915494, v8
    v_mul_f32 v9, 0.15915494, v9
    v_rndne_f32 v10, v8
    v_rndne_f32 v11, v9
    v_sub_f32 v8, v8, v10
    v_sub_f32 v9, v9, v11
    v_sin_f32 v8, v8
    v_sin_f32 v9, v9
    s_nop 0
    v_cvt_pk_bf16_f32 v10, v8, v9
    v_lshlrev_b32 v8, 16, v10
    v_and_b32 v9, 0xffff0000, v10
    v_mul_f32 v8, v8, v7
    v_mul_f32 v9, v9, v7
    v_cvt_pk_bf16_f32 v10, v8, v9
    v_lshlrev_b32 v8, 16, v10
    v_and_b32 v9, 0xffff0000, v10
    v_mul_f32 v8, v8, v6
    v_mul_f32 v9, v9, v6
    v_cvt_pk_bf16_f32 v10, v8, v9
    s_lshl_b32 s48, s23, 12
    v_lshlrev_b32 v11, 2, v0
    v_add_u32 v11, s48, v11
    buffer_store_dword v10, v11, s[32:35], 0 offen sc1
    s_cmp_ge_u32 s23, 4
    s_cbranch_scc1 L_k1_m2
    s_lshr_b32 s42, s22, 2
    s_lshl_b32 s42, s42, 10
    s_and_b32 s43, s22, 3
    s_lshl_b32 s43, s43, 2
    s_add_u32 s42, s42, s43
    s_add_u32 s42, s42, s48
    s_add_u32 s42, s42, 0x10000
    v_lshlrev_b32 v11, 4, v1
    v_add_u32 v11, s42, v11
    s_waitcnt vmcnt(1)
    v_lshl_or_b32 v24, v25, 16, v24
    buffer_store_dword v24, v11, s[32:35], 0 offen sc1
L_k1_m2:

L_fuse:
    s_setprio 0
    s_mov_b64 exec, 1
    s_mov_b32 s10, s22
    v_mov_b32 v2, 163776
    v_mov_b32 v3, 1
    v_mov_b32 v5, 0
    s_cmp_lt_u32 s2, 237
    s_cbranch_scc1 L_fu0
    s_waitcnt vmcnt(0)
    s_barrier
    s_cmp_lg_u32 s10, 0
    s_cbranch_scc1 L_fug
    buffer_atomic_add v3, v5, s[76:79], 0 offen sc1
L_fug:
    s_mov_b64 exec, -1
    s_cmp_ge_u32 s22, 10
    s_cbranch_scc1 L_rlm
    s_mov_b32 s64, s4
    s_mov_b32 s65, s5
    s_mov_b32 s66, 10240000
    s_mov_b32 s67, 0x00020000
    s_and_b32 s40, s2, 1
    s_lshl_b32 s40, s40, 5
    s_lshr_b32 s41, s2, 3
    s_add_u32 s40, s40, s41
    s_mul_i32 s40, s40, 160768
    s_lshl_b32 s41, s22, 14
    s_add_u32 s40, s40, s41
    s_bfe_u32 s41, s2, 0x20001
    s_lshl_b32 s42, s41, 6
    s_add_u32 s42, s42, s40
    v_lshrrev_b32 v116, 2, v1
    v_lshlrev_b32 v116, 10, v116
    v_and_b32 v117, 3, v1
    v_lshl_add_u32 v116, v117, 4, v116
    v_add_u32 v116, s42, v116
    buffer_load_dwordx4 v[82:85], v116, s[64:67], 0 offen offset:256
    buffer_load_dwordx4 v[86:89], v116, s[64:67], 0 offen offset:512
    buffer_load_dwordx4 v[90:93], v116, s[64:67], 0 offen offset:768
    s_lshr_b32 s42, s41, 1
    s_lshl_b32 s42, s42, 10
    s_add_u32 s40, s40, s42
    s_and_b32 s42, s41, 1
    s_lshl_b32 s42, s42, 7
    s_add_u32 s40, s40, s42
    v_lshrrev_b32 v116, 3, v1
    v_lshlrev_b32 v116, 11, v116
    v_and_b32 v117, 7, v1
    v_lshl_add_u32 v116, v117, 4, v116
    v_add_u32 v116, s40, v116
    buffer_load_dwordx4 v[94:97], v116, s[64:67], 0 offen
L_rlm:
    s_waitcnt vmcnt(0)
    s_mov_b32 s64, s4
    s_mov_b32 s65, s5
    s_mov_b32 s66, 10240000
    s_mov_b32 s67, 0x00020000
    s_and_b32 s40, s2, 1
    s_mul_i32 s40, s40, 5024
    s_sub_u32 s41, s2, 237
    s_lshr_b32 s41, s41, 3
    s_lshl_b32 s41, s41, 10
    s_add_u32 s40, s40, s41
    s_lshl_b32 s40, s40, 10
    s_bfe_u32 s41, s2, 0x10002
    s_lshl_b32 s41, s41, 7
    s_add_u32 s40, s40, s41
    v_lshl_add_u32 v67, v0, 10, s40
    s_cmp_eq_u32 s10, 0
    s_cbranch_scc1 L_hw
    buffer_load_dword v64, v67, s[64:67], 0 offen offset:256
L_hw:
    s_mov_b64 exec, 1
L_fu0:
    s_cmp_lg_u32 s10, 0
    s_cbranch_scc1 L_fu3
    s_mov_b32 s66, 0
    s_sub_u32 s65, s2, 157
    s_cmp_ge_u32 s65, 80
    s_cbranch_scc1 L_fu2
    s_waitcnt vmcnt(0)
    v_readfirstlane_b32 s65, v73
    s_nop 0
    s_cmp_ge_u32 s65, 19
    s_cbranch_scc1 L_fu3
L_fu2:
    buffer_load_dword v4, v5, s[76:79], 0 offen sc1
    s_add_u32 s66, s66, 1
    s_waitcnt vmcnt(0)
    v_readfirstlane_b32 s65, v4
    s_nop 0
    s_cmp_ge_u32 s65, 19
    s_cbranch_scc1 L_fu3
    s_sleep 16
    s_cmp_lt_u32 s66, 0x100000
    s_cbranch_scc1 L_fu2
L_fu3:
    s_cmp_ge_u32 s2, 237
    s_cbranch_scc1 L_fu1
    s_cmp_lt_u32 s2, 157
    s_cbranch_scc1 L_fu5
    s_waitcnt vmcnt(0)
    ds_add_rtn_u32 v4, v2, v3
    s_waitcnt lgkmcnt(0)
    v_readfirstlane_b32 s65, v4
    s_nop 0
    s_cmp_lg_u32 s65, 15
    s_cbranch_scc1 L_fu1
    s_mov_b64 exec, -1
    s_lshl_b32 s65, s23, 2
    v_lshl_add_u32 v6, v1, 9, s65
    buffer_store_dword v30, v6, s[72:75], 0 offen sc1
    s_branch L_fu1
L_fu5:
L_fu1:
    s_mov_b64 exec, -1
    s_mov_b32 s76, s72
    s_mov_b32 s77, s73
    s_mov_b32 s78, 49152
    s_mov_b64 s[8:9], s[20:21]
    s_mov_b64 s[6:7], s[100:101]
    s_bfe_u32 s11, s2, 0x20001
    s_lshr_b32 s13, s2, 3
    s_and_b32 s12, s2, 1
    s_lshl_b32 s12, s12, 5
    s_add_u32 s12, s12, s13
    s_mov_b32 s14, 0
    s_mov_b32 s15, 0
    s_mov_b32 s17, 0
    s_mul_i32 s65, s11, 2560000
    s_and_b32 s66, s11, 1
    s_mul_i32 s66, s66, 1280000
    s_add_u32 s66, s66, 10240000
    s_mul_i32 s67, s11, 10240000
    s_add_u32 s67, s67, 18874368
    s_mov_b32 s18, 2064383
    s_mov_b32 s19, 0
    s_waitcnt lgkmcnt(0)
    s_add_u32 s36, s8, 12800000
    s_addc_u32 s37, s9, 0
    s_mov_b32 s38, 6074368
    s_mov_b32 s39, 0x00020000
    s_add_u32 s20, s8, s65
    s_addc_u32 s21, s9, 0
    s_mov_b32 s22, 2560000
    s_mov_b32 s23, 0x00020000
    s_add_u32 s24, s8, s66
    s_addc_u32 s25, s9, 0
    s_mov_b32 s26, 1280000
    s_mov_b32 s27, 0x00020000
    s_mov_b32 s28, s4
    s_mov_b32 s29, s5
    s_mov_b32 s30, 10240000
    s_mov_b32 s31, 0x00020000
    s_mov_b32 s32, s6
    s_mov_b32 s33, s7
    s_mov_b32 s34, 10240000
    s_mov_b32 s35, 0x00020000
    s_add_u32 s40, s8, s67
    s_addc_u32 s41, s9, 0
    s_mov_b32 s42, 10240000
    s_mov_b32 s43, 0x00020000
    s_mov_b32 s71, 0
L_round:
    v_mbcnt_lo_u32_b32 v1, -1, 0
    v_mbcnt_hi_u32_b32 v1, -1, v1
    s_lshl_b32 s65, s10, 6
    v_add_u32 v0, s65, v1
    v_mul_u32_u24 v45, 683, v0
    v_lshrrev_b32 v45, 13, v45
L_noseg:
    v_mul_u32_u24 v46, 12, v45
    v_sub_u32 v46, v0, v46
    v_mul_u32_u24 v48, 57344, v45
    s_mul_i32 s65, s14, 12
    s_add_u32 s65, s65, 102400
    v_add_u32 v48, s65, v48
    s_add_u32 s72, s10, s13
    s_and_b32 s72, s72, 15
    s_lshl_b32 s72, s72, 11
    s_add_u32 s72, s72, 32768
    v_lshlrev_b32 v49, 4, v1
    v_add_u32 v58, s72, v49
    s_mov_b32 s64, s72
    v_lshrrev_b32 v75, 4, v1
    v_and_b32 v76, 15, v1
    v_lshlrev_b32 v103, 4, v76
    v_and_b32 v77, 7, v1
    v_lshlrev_b32 v104, 4, v77
    v_lshlrev_b32 v105, 3, v75
    v_bfe_u32 v78, v1, 3, 1
    v_lshlrev_b32 v113, 4, v78
    v_and_b32 v79, 3, v1
    v_lshlrev_b32 v124, 3, v79
    v_add_u32 v124, 69632, v124
    v_cmp_eq_u32 vcc, v79, v75
    v_bfe_u32 v80, v1, 2, 2
    v_lshlrev_b32 v80, 3, v80
    v_add_u32 v80, 69632, v80
    v_mov_b32 v81, 132608
    v_cndmask_b32 v125, v81, v80, vcc
    v_mov_b32 v81, 384
    v_cndmask_b32 v126, 0, v81, vcc
    v_cndmask_b32 v102, 0, 32, vcc
    v_lshlrev_b32 v122, 2, v75
    v_add_u32 v122, 150528, v122
    v_and_b32 v123, 12, v1
    v_add_u32 v123, 150528, v123
    v_lshlrev_b32 v117, 4, v1
    v_add_u32 v117, 65536, v117
    v_mov_b32 v2, 0x100
    v_lshrrev_b32 v80, 2, v76
    v_lshlrev_b32 v80, 2, v80
    v_lshl_add_u32 v80, v79, 4, v80
    v_add_u32 v120, 1024, v80
    s_lshl_b32 s65, s11, 6
    s_add_u32 s65, s65, 0x100
    v_add_u32 v114, s65, v80
    s_and_b32 s65, s11, 1
    s_lshl_b32 s65, s65, 7
    v_lshl_add_u32 v80, v78, 3, v104
    v_add_u32 v115, s65, v80
    s_lshr_b32 s67, s11, 1
    s_lshl_b32 s67, s67, 6
    s_sub_u32 s67, 151552, s67
    v_add_u32 v121, s67, v80
    s_mov_b32 m0, s64
    v_mov_b32 v52, 0
    v_mov_b32 v53, 0
    v_mov_b32 v54, 0
    v_mov_b32 v55, 0
    v_mov_b32 v60, -1
    v_mov_b32 v61, -1
    v_mov_b32 v62, -1
    v_mov_b32 v63, -1
    v_lshlrev_b32 v50, 4, v0
    v_add_u32 v51, 69632, v50
    v_add_u32 v56, 135168, v50
    s_cmp_lg_u32 s15, 0
    s_cbranch_scc1 L_in1
    s_cmp_lt_u32 s2, 157
    s_cbranch_scc1 L_in2
    s_barrier
    s_cmp_ge_u32 s10, 10
    s_cbranch_scc1 L_in1
    v_add_u32 v57, 151552, v50
    ds_write_b128 v50, v[82:85] offset:1024
    ds_write_b128 v50, v[86:89] offset:11264
    ds_write_b128 v50, v[90:93] offset:21504
    ds_write_b128 v57, v[94:97]
L_in1:
    ds_write_b128 v51, v[52:55]
    ds_write_b128 v51, v[52:55] offset:16384
    ds_write_b128 v51, v[52:55] offset:32768
    s_branch L_in3
L_in2:
    s_cmp_ge_u32 s10, 12
    s_cbranch_scc1 L_in4
    v_mov_b32 v57, 163776
L_in5:
    s_sleep 4
    ds_read_b32 v59, v57 offset:4
    s_waitcnt lgkmcnt(0)
    v_readfirstlane_b32 s65, v59
    s_nop 0
    s_cmp_lt_u32 s65, 16
    s_cbranch_scc1 L_in5
    ds_write_b128 v51, v[52:55]
    ds_write_b128 v51, v[52:55] offset:12288
    ds_write_b128 v51, v[52:55] offset:24576
    ds_write_b128 v51, v[52:55] offset:36864
L_in4:
    s_barrier
L_in3:
    ds_write_b128 v51, v[52:55] offset:49152
    ds_write_b128 v56, v[60:63]
    v_lshlrev_b32 v44, 2, v45
    v_add_u32 v44, 162816, v44
    s_waitcnt lgkmcnt(0)
    s_barrier
    s_cmp_ge_u32 s2, 157
    s_cbranch_scc1 L_fue
    s_cmp_lg_u32 s15, 0
    s_cbranch_scc1 L_fue
    v_mov_b32 v20, 163776
    v_mov_b32 v21, 1
    s_mov_b64 exec, 1
    s_waitcnt vmcnt(0)
    ds_add_rtn_u32 v22, v20, v21
    s_waitcnt lgkmcnt(0)
    v_readfirstlane_b32 s65, v22
    s_mov_b64 exec, 0xffff
    s_cmp_lg_u32 s65, 15
    s_cbranch_scc1 L_fuf
    s_lshl_b32 s65, s2, 2
    s_add_u32 s65, s65, 32768
    v_lshl_add_u32 v20, v1, 10, s65
    buffer_store_dword v21, v20, s[76:79], 0 offen sc1
L_fuf:
    s_mov_b64 exec, -1
L_fue:
    s_mov_b32 s66, 0
    s_cmp_lg_u32 s10, 15
    s_cbranch_scc1 L_fu7
    s_lshl_b32 s65, s12, 9
    v_add_u32 v44, s65, v49
    v_add_u32 v47, 162816, v49
    s_mov_b64 exec, 0xfffff
L_fu6:
    buffer_load_dwordx4 v[20:23], v44, s[76:79], 0 offen sc1
    s_add_u32 s66, s66, 1
    s_waitcnt vmcnt(0)
    v_and_b32 v24, v20, v21
    v_and_b32 v25, v22, v23
    v_and_b32 v24, v24, v25
    v_cmp_le_i32 vcc, 0, v24
    s_nop 0
    s_andn2_b64 exec, exec, vcc
    ds_write_b128 v47, v[20:23]
    s_mov_b64 exec, vcc
    s_cbranch_vccz L_fu8
    s_sleep 3
    s_cmp_lt_u32 s66, 0x100000
    s_cbranch_scc1 L_fu6
L_fu8:
    s_mov_b64 exec, -1
    s_mov_b32 s65, 0
    s_branch L_fua
L_fub:
    s_sleep 2
L_fu7:
    ds_read_b32 v47, v44
    s_add_u32 s66, s66, 1
    s_cmp_ge_u32 s66, 0x1000000
    s_waitcnt lgkmcnt(0)
    s_cbranch_scc1 L_fuc
    v_cmp_le_i32 vcc, 0, v47
    s_cbranch_vccnz L_fub
L_fuc:
    s_mov_b32 s65, 0x7fffffff
L_fua:
    v_and_b32 v47, s65, v47
    v_and_b32 v50, 0xffff, v47
    v_lshl_add_u32 v48, v50, 2, v48
    v_mad_u32_u24 v48, v46, 12, v48
    v_lshrrev_b32 v47, 16, v47
    v_sub_u32 v47, v47, v46
    s_add_u32 s65, s14, 0
    v_cmp_lt_i32 s[44:45], s65, v47
    s_add_u32 s65, s14, 12
    v_cmp_lt_i32 s[46:47], s65, v47
    s_add_u32 s65, s14, 24
    v_cmp_lt_i32 s[48:49], s65, v47
    s_add_u32 s65, s14, 36
    v_cmp_lt_i32 s[50:51], s65, v47
    s_add_u32 s65, s14, 48
    v_cmp_lt_i32 s[52:53], s65, v47
    s_add_u32 s65, s14, 60
    v_cmp_lt_i32 s[54:55], s65, v47
    s_add_u32 s65, s14, 72
    v_cmp_lt_i32 s[56:57], s65, v47
    s_mov_b64 exec, s[44:45]
    s_cbranch_execz L_ld_done
    buffer_load_dwordx3 v[64:66], v48, s[36:39], 0 offen offset:0 sc1
    s_mov_b64 exec, s[46:47]
    s_cbranch_execz L_ld_done
    buffer_load_dwordx3 v[68:70], v48, s[36:39], 0 offen offset:144 sc1
    s_mov_b64 exec, s[48:49]
    s_cbranch_execz L_ld_done
    buffer_load_dwordx3 v[72:74], v48, s[36:39], 0 offen offset:288 sc1
    s_mov_b64 exec, s[50:51]
    s_cbranch_execz L_ld_done
    buffer_load_dwordx3 v[76:78], v48, s[36:39], 0 offen offset:432 sc1
    s_mov_b64 exec, s[52:53]
    s_cbranch_execz L_ld_done
    buffer_load_dwordx3 v[80:82], v48, s[36:39], 0 offen offset:576 sc1
    s_mov_b64 exec, s[54:55]
    s_cbranch_execz L_ld_done
    buffer_load_dwordx3 v[84:86], v48, s[36:39], 0 offen offset:720 sc1
    s_mov_b64 exec, s[56:57]
    s_cbranch_execz L_ld_done
    buffer_load_dwordx3 v[88:90], v48, s[36:39], 0 offen offset:864 sc1
L_ld_done:
    s_mov_b64 exec, -1
    s_cmp_lg_u32 s17, 0
    s_cbranch_scc1 L_maskdone
    v_mov_b32 v127, 0
L_maskret:
    s_add_u32 s65, s14, 84
    v_cmp_lt_i32 vcc, s65, v47
    v_mov_b32 v118, 1
    v_mov_b32 v119, 132672
    buffer_load_dwordx4 v[4:7], v58, s[36:39], 0 offen sc1
    buffer_load_dwordx4 v[8:11], v58, s[36:39], 0 offen offset:1024 sc1
    v_mov_b32 v16, v58
    s_cmp_lt_u32 s10, 11
    s_cbranch_scc1 L_bk2
    s_sub_u32 s66, s10, 11
    s_lshl_b32 s66, s66, 10
    s_add_u32 s66, s66, 65536
    s_lshl_b32 s67, s11, 12
    s_add_u32 s67, s67, s66
    s_cmp_eq_u32 s10, 15
    s_cselect_b32 s66, 0, s66
    s_cselect_b32 s67, 0, s67
    s_mov_b32 m0, s66
    v_add_u32 v58, s67, v49
    v_add_u32 v17, s66, v49
    buffer_load_dwordx4 v[12:15], v58, s[36:39], 0 offen sc1
    s_waitcnt vmcnt(3)
    s_branch L_bf2
L_bk2:
    s_waitcnt vmcnt(2)
L_bf2:
    s_mov_b64 exec, vcc
    ds_write_b32 v119, v118
    s_mov_b32 s72, 2080374784
    s_mov_b64 s[66:67], 0
    s_mov_b64 exec, s[44:45]
    s_cbranch_execz L_rk0
    v_and_b32 v50, 0xff, v66
    v_lshlrev_b32 v58, 2, v50
    v_add_u32 v58, 131072, v58
    ds_add_rtn_u32 v67, v58, v118
    v_subrev_u32 v58, 67108864, v65
    v_cmp_gt_u32 vcc, s72, v58
    s_nop 0
    s_or_b64 s[66:67], s[66:67], vcc
    v_mul_u32_u24 v50, 48, v50
    v_lshrrev_b32 v66, 8, v66
L_rk0:
    s_mov_b64 exec, s[46:47]
    s_cbranch_execz L_rk1
    v_and_b32 v51, 0xff, v70
    v_lshlrev_b32 v58, 2, v51
    v_add_u32 v58, 131072, v58
    ds_add_rtn_u32 v71, v58, v118
    v_subrev_u32 v58, 67108864, v69
    v_cmp_gt_u32 vcc, s72, v58
    s_nop 0
    s_or_b64 s[66:67], s[66:67], vcc
    v_mul_u32_u24 v51, 48, v51
    v_lshrrev_b32 v70, 8, v70
L_rk1:
    s_mov_b64 exec, s[48:49]
    s_cbranch_execz L_rk2
    v_and_b32 v52, 0xff, v74
    v_lshlrev_b32 v58, 2, v52
    v_add_u32 v58, 131072, v58
    ds_add_rtn_u32 v75, v58, v118
    v_subrev_u32 v58, 67108864, v73
    v_cmp_gt_u32 vcc, s72, v58
    s_nop 0
    s_or_b64 s[66:67], s[66:67], vcc
    v_mul_u32_u24 v52, 48, v52
    v_lshrrev_b32 v74, 8, v74
L_rk2:
    s_mov_b64 exec, s[50:51]
    s_cbranch_execz L_rk3
    v_and_b32 v53, 0xff, v78
    v_lshlrev_b32 v58, 2, v53
    v_add_u32 v58, 131072, v58
    ds_add_rtn_u32 v79, v58, v118
    v_subrev_u32 v58, 67108864, v77
    v_cmp_gt_u32 vcc, s72, v58
    s_nop 0
    s_or_b64 s[66:67], s[66:67], vcc
    v_mul_u32_u24 v53, 48, v53
    v_lshrrev_b32 v78, 8, v78
L_rk3:
    s_mov_b64 exec, s[52:53]
    s_cbranch_execz L_rk4
    v_and_b32 v54, 0xff, v82
    v_lshlrev_b32 v58, 2, v54
    v_add_u32 v58, 131072, v58
    ds_add_rtn_u32 v83, v58, v118
    v_subrev_u32 v58, 67108864, v81
    v_cmp_gt_u32 vcc, s72, v58
    s_nop 0
    s_or_b64 s[66:67], s[66:67], vcc
    v_mul_u32_u24 v54, 48, v54
    v_lshrrev_b32 v82, 8, v82
L_rk4:
    s_mov_b64 exec, s[54:55]
    s_cbranch_execz L_rk5
    v_and_b32 v55, 0xff, v86
    v_lshlrev_b32 v58, 2, v55
    v_add_u32 v58, 131072, v58
    ds_add_rtn_u32 v87, v58, v118
    v_subrev_u32 v58, 67108864, v85
    v_cmp_gt_u32 vcc, s72, v58
    s_nop 0
    s_or_b64 s[66:67], s[66:67], vcc
    v_mul_u32_u24 v55, 48, v55
    v_lshrrev_b32 v86, 8, v86
L_rk5:
    s_mov_b64 exec, s[56:57]
    s_cbranch_execz L_rk6
    v_and_b32 v56, 0xff, v90
    v_lshlrev_b32 v58, 2, v56
    v_add_u32 v58, 131072, v58
    ds_add_rtn_u32 v91, v58, v118
    v_subrev_u32 v58, 67108864, v89
    v_cmp_gt_u32 vcc, s72, v58
    s_nop 0
    s_or_b64 s[66:67], s[66:67], vcc
    v_mul_u32_u24 v56, 48, v56
    v_lshrrev_b32 v90, 8, v90
L_rk6:
    s_cmp_lg_u64 s[66:67], 0
    s_cbranch_scc1 L_cp
L_cpret:
    s_mov_b64 exec, 1
    ds_add_u32 v119, v118 offset:12
    s_mov_b64 exec, -1
    s_waitcnt lgkmcnt(1)
    s_cmp_eq_u32 s10, 15
    s_cbranch_scc1 L_np
    s_mov_b64 s[66:67], 0
    s_mov_b32 s72, 69632
    s_mov_b32 s73, 135168
    s_mov_b64 exec, s[44:45]
    s_cbranch_execz L_pl0
    v_cmp_gt_u32 vcc, 48, v67
    v_add_u32 v50, v50, v67
    s_andn2_b64 s[44:45], exec, vcc
    s_or_b64 s[66:67], s[66:67], s[44:45]
    s_mov_b64 exec, vcc
    v_lshl_add_u32 v58, v50, 3, s72
    v_lshl_add_u32 v59, v50, 1, s73
    ds_write_b64 v58, v[64:65]
    ds_write_b16 v59, v66
    v_or_b32 v127, 1, v127
L_pl0:
    s_mov_b64 exec, s[46:47]
    s_cbranch_execz L_pl1
    v_cmp_gt_u32 vcc, 48, v71
    v_add_u32 v51, v51, v71
    s_andn2_b64 s[46:47], exec, vcc
    s_or_b64 s[66:67], s[66:67], s[46:47]
    s_mov_b64 exec, vcc
    v_lshl_add_u32 v58, v51, 3, s72
    v_lshl_add_u32 v59, v51, 1, s73
    ds_write_b64 v58, v[68:69]
    ds_write_b16 v59, v70
    v_or_b32 v127, 2, v127
L_pl1:
    s_mov_b64 exec, s[48:49]
    s_cbranch_execz L_pl2
    v_cmp_gt_u32 vcc, 48, v75
    v_add_u32 v52, v52, v75
    s_andn2_b64 s[48:49], exec, vcc
    s_or_b64 s[66:67], s[66:67], s[48:49]
    s_mov_b64 exec, vcc
    v_lshl_add_u32 v58, v52, 3, s72
    v_lshl_add_u32 v59, v52, 1, s73
    ds_write_b64 v58, v[72:73]
    ds_write_b16 v59, v74
    v_or_b32 v127, 4, v127
L_pl2:
    s_mov_b64 exec, s[50:51]
    s_cbranch_execz L_pl3
    v_cmp_gt_u32 vcc, 48, v79
    v_add_u32 v53, v53, v79
    s_andn2_b64 s[50:51], exec, vcc
    s_or_b64 s[66:67], s[66:67], s[50:51]
    s_mov_b64 exec, vcc
    v_lshl_add_u32 v58, v53, 3, s72
    v_lshl_add_u32 v59, v53, 1, s73
    ds_write_b64 v58, v[76:77]
    ds_write_b16 v59, v78
    v_or_b32 v127, 8, v127
L_pl3:
    s_mov_b64 exec, s[52:53]
    s_cbranch_execz L_pl4
    v_cmp_gt_u32 vcc, 48, v83
    v_add_u32 v54, v54, v83
    s_andn2_b64 s[52:53], exec, vcc
    s_or_b64 s[66:67], s[66:67], s[52:53]
    s_mov_b64 exec, vcc
    v_lshl_add_u32 v58, v54, 3, s72
    v_lshl_add_u32 v59, v54, 1, s73
    ds_write_b64 v58, v[80:81]
    ds_write_b16 v59, v82
    v_or_b32 v127, 16, v127
L_pl4:
    s_mov_b64 exec, s[54:55]
    s_cbranch_execz L_pl5
    v_cmp_gt_u32 vcc, 48, v87
    v_add_u32 v55, v55, v87
    s_andn2_b64 s[54:55], exec, vcc
    s_or_b64 s[66:67], s[66:67], s[54:55]
    s_mov_b64 exec, vcc
    v_lshl_add_u32 v58, v55, 3, s72
    v_lshl_add_u32 v59, v55, 1, s73
    ds_write_b64 v58, v[84:85]
    ds_write_b16 v59, v86
    v_or_b32 v127, 32, v127
L_pl5:
    s_mov_b64 exec, s[56:57]
    s_cbranch_execz L_pl6
    v_cmp_gt_u32 vcc, 48, v91
    v_add_u32 v56, v56, v91
    s_andn2_b64 s[56:57], exec, vcc
    s_or_b64 s[66:67], s[66:67], s[56:57]
    s_mov_b64 exec, vcc
    v_lshl_add_u32 v58, v56, 3, s72
    v_lshl_add_u32 v59, v56, 1, s73
    ds_write_b64 v58, v[88:89]
    ds_write_b16 v59, v90
    v_or_b32 v127, 64, v127
L_pl6:
    s_cmp_lg_u64 s[66:67], 0
    s_cbranch_scc1 L_ext
L_extret:
    s_mov_b64 exec, -1
    s_waitcnt vmcnt(0)
    s_cmp_ge_u32 s2, 157
    s_cbranch_scc1 L_np_done
    s_cmp_lg_u32 s15, 0
    s_cbranch_scc1 L_np_done
    s_mul_i32 s72, s12, 160768
    s_cmp_ge_u32 s10, 10
    s_cbranch_scc1 L_rs2g
    s_lshl_b32 s65, s10, 14
    s_add_u32 s65, s65, s72
    s_lshl_b32 s66, s11, 6
    s_add_u32 s65, s65, s66
    s_add_u32 s65, s65, 0x100
    v_lshrrev_b32 v60, 2, v1
    v_lshlrev_b32 v60, 10, v60
    v_and_b32 v61, 3, v1
    v_lshl_add_u32 v60, v61, 4, v60
    v_add_u32 v60, s65, v60
    s_lshl_b32 s66, s10, 10
    s_add_u32 s67, s66, 1024
    s_mov_b32 m0, s67
    s_nop 0
    buffer_load_dwordx4 v60, s[28:31], 0 offen offset:0 lds
    s_add_u32 s67, s66, 11008
    s_mov_b32 m0, s67
    s_nop 0
    buffer_load_dwordx4 v60, s[28:31], 0 offen offset:256 lds
    s_add_u32 s67, s66, 20992
    s_mov_b32 m0, s67
    s_nop 0
    buffer_load_dwordx4 v60, s[28:31], 0 offen offset:512 lds
    s_branch L_rs3g
L_rs2g:
    s_cmp_ge_u32 s10, 14
    s_cbranch_scc1 L_rs3g
    s_sub_u32 s73, s10, 10
    s_mul_i32 s73, s73, 3
    s_min_u32 s73, s73, 7
    s_lshl_b32 s65, s73, 14
    s_add_u32 s65, s65, s72
    s_lshr_b32 s66, s11, 1
    s_lshl_b32 s66, s66, 10
    s_add_u32 s65, s65, s66
    s_and_b32 s66, s11, 1
    s_lshl_b32 s66, s66, 7
    s_add_u32 s65, s65, s66
    v_lshrrev_b32 v60, 3, v1
    v_lshlrev_b32 v60, 11, v60
    v_and_b32 v61, 7, v1
    v_lshl_add_u32 v60, v61, 4, v60
    v_add_u32 v60, s65, v60
    v_add_u32 v61, 15360, v60
    v_add_u32 v62, 30720, v60
    s_lshl_b32 s66, s73, 10
    s_add_u32 s66, s66, 151552
    s_mov_b32 m0, s66
    s_nop 0
    buffer_load_dwordx4 v60, s[28:31], 0 offen lds
    buffer_load_dwordx4 v61, s[28:31], 0 offen offset:1024 lds
    buffer_load_dwordx4 v62, s[28:31], 0 offen offset:2048 lds
L_rs3g:
    s_branch L_np_done
L_np:
    s_setprio 3
    v_lshlrev_b32 v80, 2, v1
    v_add_u32 v81, 131072, v80
    v_writelane_b32 v90, 0, 0
    v_writelane_b32 v90, 1, 1
    v_writelane_b32 v90, 2, 2
    v_writelane_b32 v90, 3, 3
    v_writelane_b32 v90, 4, 4
    v_writelane_b32 v90, 5, 5
    v_writelane_b32 v90, 6, 6
    v_writelane_b32 v90, 7, 7
    v_writelane_b32 v90, 8, 8
    v_writelane_b32 v90, 9, 9
    v_writelane_b32 v90, 10, 10
    v_writelane_b32 v90, 11, 11
    v_writelane_b32 v90, 12, 12
    v_writelane_b32 v90, 13, 13
    v_writelane_b32 v90, 14, 14
    v_writelane_b32 v90, 16, 15
    v_writelane_b32 v90, 17, 16
    v_writelane_b32 v90, 18, 17
    v_writelane_b32 v90, 19, 18
    v_writelane_b32 v90, 20, 19
    v_writelane_b32 v90, 15, 20
    v_writelane_b32 v90, 21, 21
    v_writelane_b32 v90, 22, 22
    v_writelane_b32 v90, 23, 23
    v_writelane_b32 v90, 24, 24
    v_writelane_b32 v90, 25, 25
    v_writelane_b32 v90, 26, 26
    v_writelane_b32 v90, 27, 27
    v_writelane_b32 v90, 28, 28
    v_writelane_b32 v90, 29, 29
    v_writelane_b32 v90, 30, 30
    v_writelane_b32 v90, 31, 31
    v_writelane_b32 v90, 32, 32
    v_writelane_b32 v90, 33, 33
    v_writelane_b32 v90, 34, 34
    v_writelane_b32 v90, 35, 35
    v_writelane_b32 v90, 36, 36
    v_writelane_b32 v90, 37, 37
    v_writelane_b32 v90, 38, 38
    v_writelane_b32 v90, 39, 39
    s_mov_b32 s66, 0
    s_and_b32 s65, s2, 15
    s_lshl_b32 s65, s65, 10
    s_add_u32 s65, s65, 32768
    v_lshl_add_u32 v64, v1, 4, s65
    s_mov_b32 exec_lo, -1
    s_mov_b32 exec_hi, 0xff
L_tw:
    buffer_load_dwordx4 v[60:63], v64, s[76:79], 0 offen sc1
    s_add_u32 s66, s66, 1
    s_waitcnt vmcnt(0)
    v_and_b32 v60, v60, v61
    v_and_b32 v62, v62, v63
    v_and_b32 v60, v60, v62
    v_cmp_eq_u32 vcc, 0, v60
    s_cbranch_vccz L_tw2
    s_sleep 3
    s_cmp_lt_u32 s66, 0x100000
    s_cbranch_scc1 L_tw
L_tw2:
    s_mov_b64 exec, -1
L_npw:
    s_sleep 1
    ds_read_b32 v60, v119 offset:12
    s_waitcnt lgkmcnt(0)
    v_readfirstlane_b32 s65, v60
    s_nop 0
    s_cmp_lt_u32 s65, 16
    s_cbranch_scc1 L_npw
    ds_read_b32 v60, v81
    ds_read_b32 v61, v81 offset:256
    ds_read_b32 v62, v81 offset:512
    s_mul_i32 s72, s12, 157
    s_sub_u32 s65, 10000, s72
    s_min_u32 s65, s65, 157
    s_lshr_b32 s73, s11, 1
    v_xor_b32 v69, s73, v1
    v_and_b32 v69, 1, v69
    v_lshlrev_b32 v70, 8, v69
    v_add_u32 v70, 132096, v70
    v_cmp_gt_u32 s[44:45], s65, v1
    v_add_u32 v82, 64, v1
    v_cmp_gt_u32 s[46:47], s65, v82
    v_add_u32 v82, 0x80, v1
    v_cmp_gt_u32 s[48:49], s65, v82
    s_waitcnt lgkmcnt(0)
    v_min_u32 v60, 63, v60
    v_sub_u32 v63, 63, v60
    v_add_u32 v82, 1, v60
    v_and_b32 v82, 64, v82
    v_add_u32 v60, v60, v82
    v_lshlrev_b32 v63, 2, v63
    v_add_u32 v82, v70, v63
    s_mov_b64 exec, s[44:45]
    ds_add_rtn_u32 v66, v82, v118
    s_mov_b64 exec, -1
    v_min_u32 v61, 63, v61
    v_sub_u32 v64, 63, v61
    v_add_u32 v83, 1, v61
    v_and_b32 v83, 64, v83
    v_add_u32 v61, v61, v83
    v_lshlrev_b32 v64, 2, v64
    v_add_u32 v83, v70, v64
    s_mov_b64 exec, s[46:47]
    ds_add_rtn_u32 v67, v83, v118
    s_mov_b64 exec, -1
    v_min_u32 v62, 63, v62
    v_sub_u32 v65, 63, v62
    v_add_u32 v84, 1, v62
    v_and_b32 v84, 64, v84
    v_add_u32 v62, v62, v84
    v_lshlrev_b32 v65, 2, v65
    v_add_u32 v84, v70, v65
    s_mov_b64 exec, s[48:49]
    ds_add_rtn_u32 v68, v84, v118
    s_mov_b64 exec, -1
    v_add_u32 v81, 132096, v80
    ds_read2_b32 v[72:73], v81 offset0:0 offset1:64
    v_lshlrev_b32 v85, 4, v69
    v_cmp_eq_u32 vcc, 0, v69
    v_add_u32 v74, 0, v1
    v_lshl_or_b32 v60, v60, 8, v74
    v_add_u32 v74, 64, v1
    v_lshl_or_b32 v61, v61, 8, v74
    v_add_u32 v74, 128, v1
    v_lshl_or_b32 v62, v62, 8, v74
    s_waitcnt lgkmcnt(0)
    v_lshl_or_b32 v71, v73, 16, v72
    v_mov_b32 v72, v71
    s_nop 1
    v_add_u32_dpp v72, v72, v72 row_shr:1 row_mask:0xf bank_mask:0xf
    s_nop 1
    v_add_u32_dpp v72, v72, v72 row_shr:2 row_mask:0xf bank_mask:0xf
    s_nop 1
    v_add_u32_dpp v72, v72, v72 row_shr:4 row_mask:0xf bank_mask:0xf
    s_nop 1
    v_add_u32_dpp v72, v72, v72 row_shr:8 row_mask:0xf bank_mask:0xf
    s_nop 1
    v_add_u32_dpp v72, v72, v72 row_bcast:15 row_mask:0xa bank_mask:0xf
    s_nop 1
    v_add_u32_dpp v72, v72, v72 row_bcast:31 row_mask:0xc bank_mask:0xf
    v_sub_u32 v72, v72, v71
    ds_bpermute_b32 v82, v63, v72
    ds_bpermute_b32 v83, v64, v72
    ds_bpermute_b32 v84, v65, v72
    s_waitcnt lgkmcnt(0)
    v_mul_u32_u24 v86, 80, v69
    v_bfe_u32 v82, v82, v85, 16
    v_add_u32 v66, v66, v82
    v_and_b32 v77, -4, v66
    v_add_u32 v77, v77, v86
    ds_bpermute_b32 v82, v77, v90
    v_and_b32 v66, 3, v66
    v_bfe_u32 v83, v83, v85, 16
    v_add_u32 v67, v67, v83
    v_and_b32 v77, -4, v67
    v_add_u32 v77, v77, v86
    ds_bpermute_b32 v83, v77, v90
    v_and_b32 v67, 3, v67
    v_bfe_u32 v84, v84, v85, 16
    v_add_u32 v68, v68, v84
    v_and_b32 v77, -4, v68
    v_add_u32 v77, v77, v86
    ds_bpermute_b32 v84, v77, v90
    v_and_b32 v68, 3, v68
    s_waitcnt lgkmcnt(0)
    v_lshl_add_u32 v88, v82, 2, v66
    v_lshlrev_b32 v88, 2, v88
    v_add_u32 v88, 150528, v88
    s_mov_b64 exec, s[44:45]
    ds_write_b32 v88, v60
    s_mov_b64 exec, -1
    v_lshl_add_u32 v88, v83, 2, v67
    v_lshlrev_b32 v88, 2, v88
    v_add_u32 v88, 150528, v88
    s_mov_b64 exec, s[46:47]
    ds_write_b32 v88, v61
    s_mov_b64 exec, -1
    v_lshl_add_u32 v88, v84, 2, v68
    v_lshlrev_b32 v88, 2, v88
    v_add_u32 v88, 150528, v88
    s_mov_b64 exec, s[48:49]
    ds_write_b32 v88, v62
    s_mov_b64 exec, -1
    s_setprio 0
    s_waitcnt vmcnt(0)
L_np_done:
    v_cmp_gt_u32 vcc, 63872, v16
    s_nop 0
    s_mov_b64 exec, vcc
    ds_write_b128 v16, v[4:7]
    v_cmp_gt_u32 vcc, 62848, v16
    s_nop 0
    s_mov_b64 exec, vcc
    ds_write_b128 v16, v[8:11] offset:1024
    s_mov_b64 exec, -1
    s_cmp_lt_u32 s10, 11
    s_cbranch_scc1 L_nw3
    ds_write_b128 v17, v[12:15]
L_nw3:
    v_mov_b32 v0, v114
    v_mov_b32 v1, v115
    s_mul_i32 s75, s12, 160768
    s_mov_b32 s59, s10
    s_mov_b32 s63, 0
    s_mov_b32 s74, 0
    s_cmp_lt_u32 s10, 14
    s_cselect_b32 s3, 1, 0
    s_waitcnt lgkmcnt(0)
    s_barrier
    ds_read_b128 v[60:63], v119
    ds_read_b128 v[4:7], v117
    ds_read_b128 v[8:11], v117 offset:1024
    ds_read_b128 v[12:15], v117 offset:2048
    ds_read_b128 v[16:19], v117 offset:3072
    s_mov_b32 s56, -1
    s_waitcnt lgkmcnt(4)
    v_readfirstlane_b32 s16, v60
    v_readfirstlane_b32 s65, v61
    s_nop 0
    s_or_b32 s71, s71, s65
    v_readfirstlane_b32 s17, v62
    s_cmp_lg_u32 s71, 0
    s_cbranch_scc1 L_coldload
    s_branch L_desc
L_group:
    s_cmp_ge_u32 s59, 40
    s_cbranch_scc1 L_done
    s_mov_b32 s56, s60
    s_mov_b32 s53, s59
    s_sub_u32 s54, s60, 44
    s_cmp_gt_u32 s60, 48
    s_cselect_b32 s65, 4, 0
    s_or_b32 s3, s3, s65
    s_bitcmp1_b64 s[18:19], s59
    s_cselect_b32 s70, 1, 0
    v_mov_b32 v106, v107
    v_mov_b32 v100, v101
    s_mov_b32 s64, s63
    s_cmp_lg_u32 s63, 0
    s_cbranch_scc1 L_nofill
    s_cmp_eq_u32 s56, 0
    s_cbranch_scc1 L_nofill
    ds_read_b64 v[76:77], v98
    ds_read_u16 v78, v99 offset:6
    v_add_u32 v98, 8, v98
    v_add_u32 v99, 32, v99
    s_waitcnt lgkmcnt(0)
    v_mad_u32_u16 v80, v76, v2, v103 op_sel:[0,0,0,0]
    v_mad_u32_u16 v81, v76, v2, v103 op_sel:[1,0,0,0]
    v_mad_u32_u16 v82, v77, v2, v103 op_sel:[0,0,0,0]
    v_mad_u32_u16 v83, v77, v2, v103 op_sel:[1,0,0,0]
    buffer_load_dwordx4 v[20:23], v80, s[20:23], 0 offen sc1
    buffer_load_dwordx4 v[24:27], v81, s[20:23], 0 offen sc1
    buffer_load_dwordx4 v[28:31], v82, s[20:23], 0 offen sc1
    buffer_load_dwordx4 v[32:35], v83, s[20:23], 0 offen sc1
    v_add_u32 v79, v78, v105
    ds_read_b64 v[72:73], v79
    s_cmp_eq_u32 s70, 0
    s_cbranch_scc1 L_nofill
    v_bfe_u32 v84, v76, v113, 16
    v_lshl_add_u32 v84, v84, 7, v104
    v_bfe_u32 v85, v77, v113, 16
    v_lshl_add_u32 v85, v85, 7, v104
    buffer_load_dwordx4 v[36:39], v84, s[24:27], 0 offen sc1
    buffer_load_dwordx4 v[40:43], v85, s[24:27], 0 offen sc1
L_nofill:
    v_mov_b32 v60, 0
    v_mov_b32 v61, 0
    v_mov_b32 v62, 0
    v_mov_b32 v63, 0
    v_mov_b32 v64, 0
    v_mov_b32 v65, 0
    v_mov_b32 v66, 0
    v_mov_b32 v67, 0
    v_mov_b32 v68, 0
    v_mov_b32 v69, 0
    v_mov_b32 v70, 0
    v_mov_b32 v71, 0
    s_mov_b32 s69, s70
    s_cmp_gt_u32 s56, 4
    s_cbranch_scc1 L_disp
L_pull:
    s_cmp_lg_u32 s74, 0
    s_cbranch_scc1 L_pull2
    s_cmp_lg_u32 s3, 0
    s_cbranch_scc1 L_resforce
L_pull1:
    ds_read_b32 v114, v119 offset:20
    s_waitcnt lgkmcnt(0)
    v_readfirstlane_b32 s65, v114
    s_nop 0
    s_cmp_lt_u32 s65, 14
    s_cbranch_scc1 L_pull1
    s_mov_b32 s74, 1
L_pull2:
    s_mov_b64 exec, 1
    ds_add_rtn_u32 v114, v119, v118 offset:16
    s_mov_b64 exec, -1
    v_add_u32 v116, v3, v120
    v_add_u32 v117, v3, v121
    ds_read_b32 v110, v116
    ds_read_b32 v111, v116 offset:10240
    ds_read_b32 v112, v116 offset:20480
    ds_read_b64 v[108:109], v117
    s_waitcnt lgkmcnt(4)
    v_readfirstlane_b32 s59, v114
    s_nop 0
    s_add_u32 s59, s59, 16
    s_min_u32 s59, s59, 40
L_desc:
    s_lshl_b32 s65, s59, 4
    v_add_u32 v114, s65, v122
    v_add_u32 v115, s65, v123
    ds_read_b32 v114, v114
    ds_read_b32 v115, v115
    s_movk_i32 s66, 96
    s_movk_i32 s67, 384
    s_waitcnt lgkmcnt(0)
    v_readfirstlane_b32 s60, v114
    v_and_b32 v116, 0xff, v114
    v_and_b32 v115, 0xff, v115
    v_lshl_add_u32 v107, v116, 10, s75
    v_and_b32 v114, 0x40000000, v114
    v_or_b32 v107, v107, v114
    v_min_u32 v116, 0x9f, v116
    v_min_u32 v115, 0x9f, v115
    v_lshlrev_b32 v3, 6, v116
    v_mul_u32_u24 v98, s66, v116
    v_add_u32 v98, 135168, v98
    v_mad_u32_u24 v99, v115, s67, v124
    v_mad_u32_u24 v101, v116, v126, v125
    s_ashr_i32 s60, s60, 8
    s_max_i32 s60, s60, 0
    s_min_u32 s60, s60, 96
    s_min_u32 s61, s60, 4
    s_cmp_eq_u32 s56, -1
    s_cbranch_scc1 L_sort
    s_bitcmp1_b64 s[18:19], s59
    s_cselect_b32 s69, s61, 0
    s_mov_b32 s63, 0
    s_cmp_eq_u32 s56, 0
    s_cbranch_scc1 L_flush
    s_mov_b32 s63, s61
L_disp:
    s_cmp_eq_u32 s70, 0
    s_cbranch_scc1 L_bodyP
L_bodyD:
    s_min_u32 s57, s56, 4
    s_sub_u32 s56, s56, s57
    s_min_u32 s58, s56, 4
    s_cmp_eq_u32 s56, 0
    s_cselect_b32 s58, s61, s58
    s_waitcnt lgkmcnt(0)
    v_mfma_f32_16x16x16_bf16 v[44:47], v[72:73], v[4:5], 0
    v_mfma_f32_16x16x16_bf16 v[48:51], v[72:73], v[6:7], 0
    v_mfma_f32_16x16x16_bf16 v[52:55], v[72:73], v[8:9], 0
    v_mfma_f32_16x16x16_bf16 v[56:59], v[72:73], v[10:11], 0
    ds_read_b64 v[76:77], v98
    ds_read_u16 v78, v99 offset:6
    ds_read_b64_tr_b16 v[74:75], v100
    v_add_u32 v98, 8, v98
    v_add_u32 v99, 32, v99
    v_add_u32 v100, v102, v100
    s_mov_b32 s68, s64
    s_cmp_lg_u32 s64, 0
    s_cbranch_scc1 L_w1D
    s_waitcnt vmcnt(2)
L_w1D:
    s_waitcnt vmcnt(5) lgkmcnt(1)
    s_mov_b32 s64, 0
    v_add_u32 v79, v78, v105
    v_mad_u32_u16 v80, v76, v2, v103 op_sel:[0,0,0,0]
    v_mad_u32_u16 v81, v76, v2, v103 op_sel:[1,0,0,0]
    v_mad_u32_u16 v82, v77, v2, v103 op_sel:[0,0,0,0]
    v_mad_u32_u16 v83, v77, v2, v103 op_sel:[1,0,0,0]
    v_lshlrev_b64 v[86:87], 16, v[20:21]
    v_lshlrev_b64 v[88:89], 16, v[22:23]
    v_fmac_f32 v61, v44, v20
    v_fmac_f32 v62, v44, v21
    v_fmac_f32 v65, v48, v22
    v_fmac_f32 v66, v48, v23
    v_fmac_f32 v60, v44, v87
    v_fmac_f32 v64, v48, v89
    v_mul_f32 v52, v52, v86
    v_mul_f32 v56, v56, v88
L_ncD0:
    s_cmp_le_u32 s58, 0
    s_cbranch_scc1 L_nlD0
    buffer_load_dwordx4 v[20:23], v80, s[20:23], 0 offen sc1
L_nlD0:
    s_cmp_le_u32 s57, 1
    s_cbranch_scc1 L_ncD1
    v_lshlrev_b64 v[90:91], 16, v[24:25]
    v_lshlrev_b64 v[92:93], 16, v[26:27]
    v_fmac_f32 v61, v45, v24
    v_fmac_f32 v62, v45, v25
    v_fmac_f32 v65, v49, v26
    v_fmac_f32 v66, v49, v27
    v_fmac_f32 v60, v45, v91
    v_fmac_f32 v64, v49, v93
    v_mul_f32 v53, v53, v90
    v_mul_f32 v57, v57, v92
L_ncD1:
    s_cmp_le_u32 s58, 1
    s_cbranch_scc1 L_nlD1
    buffer_load_dwordx4 v[24:27], v81, s[20:23], 0 offen sc1
L_nlD1:
    s_cmp_le_u32 s57, 2
    s_cbranch_scc1 L_ncD2
    v_lshlrev_b64 v[86:87], 16, v[28:29]
    v_lshlrev_b64 v[88:89], 16, v[30:31]
    v_fmac_f32 v61, v46, v28
    v_fmac_f32 v62, v46, v29
    v_fmac_f32 v65, v50, v30
    v_fmac_f32 v66, v50, v31
    v_fmac_f32 v60, v46, v87
    v_fmac_f32 v64, v50, v89
    v_mul_f32 v54, v54, v86
    v_mul_f32 v58, v58, v88
L_ncD2:
    s_cmp_le_u32 s58, 2
    s_cbranch_scc1 L_nlD2
    buffer_load_dwordx4 v[28:31], v82, s[20:23], 0 offen sc1
L_nlD2:
    s_cmp_le_u32 s57, 3
    s_cbranch_scc1 L_ncD3
    v_lshlrev_b64 v[90:91], 16, v[32:33]
    v_lshlrev_b64 v[92:93], 16, v[34:35]
    v_fmac_f32 v61, v47, v32
    v_fmac_f32 v62, v47, v33
    v_fmac_f32 v65, v51, v34
    v_fmac_f32 v66, v51, v35
    v_fmac_f32 v60, v47, v91
    v_fmac_f32 v64, v51, v93
    v_mul_f32 v55, v55, v90
    v_mul_f32 v59, v59, v92
L_ncD3:
    s_cmp_le_u32 s58, 3
    s_cbranch_scc1 L_nlD3
    buffer_load_dwordx4 v[32:35], v83, s[20:23], 0 offen sc1
L_nlD3:
    v_cvt_pk_bf16_f32 v94, v52, v53
    v_cvt_pk_bf16_f32 v95, v54, v55
    v_cvt_pk_bf16_f32 v96, v56, v57
    v_cvt_pk_bf16_f32 v97, v58, v59
    s_waitcnt lgkmcnt(0)
    v_mfma_f32_16x16x16_bf16 v[44:47], v[72:73], v[12:13], 0
    v_mfma_f32_16x16x16_bf16 v[48:51], v[72:73], v[14:15], 0
    v_mfma_f32_16x16x16_bf16 v[52:55], v[72:73], v[16:17], 0
    v_mfma_f32_16x16x16_bf16 v[56:59], v[72:73], v[18:19], 0
    v_mfma_f32_16x16x16_bf16 v[60:63], v[74:75], v[94:95], v[60:63]
    v_mfma_f32_16x16x16_bf16 v[64:67], v[74:75], v[96:97], v[64:67]
    ds_read_b64 v[72:73], v79
    s_cbranch_scc1 L_dwx
    s_cmp_lg_u32 s68, 0
    s_cbranch_scc1 L_dw7
    s_waitcnt vmcnt(4)
L_dw7:
    s_waitcnt vmcnt(7)
    v_mov_b32 v86, v36
    v_mov_b32 v87, v37
    v_mov_b32 v88, v40
    v_mov_b32 v89, v41
    v_mov_b32_dpp v36, v38 row_ror:8 row_mask:0xf bank_mask:0xc
    v_mov_b32_dpp v37, v39 row_ror:8 row_mask:0xf bank_mask:0xc
    v_mov_b32_dpp v40, v42 row_ror:8 row_mask:0xf bank_mask:0xc
    v_mov_b32_dpp v41, v43 row_ror:8 row_mask:0xf bank_mask:0xc
    v_mov_b32_dpp v38, v86 row_ror:8 row_mask:0xf bank_mask:0x3
    v_mov_b32_dpp v39, v87 row_ror:8 row_mask:0xf bank_mask:0x3
    v_mov_b32_dpp v42, v88 row_ror:8 row_mask:0xf bank_mask:0x3
    v_mov_b32_dpp v43, v89 row_ror:8 row_mask:0xf bank_mask:0x3
    v_lshlrev_b64 v[86:87], 16, v[36:37]
    v_lshlrev_b64 v[88:89], 16, v[38:39]
    v_lshlrev_b64 v[90:91], 16, v[40:41]
    v_lshlrev_b64 v[92:93], 16, v[42:43]
    v_bfe_u32 v84, v76, v113, 16
    v_lshl_add_u32 v84, v84, 7, v104
    v_bfe_u32 v85, v77, v113, 16
    v_lshl_add_u32 v85, v85, 7, v104
    v_fmac_f32 v71, v48, v36
    v_fmac_f32 v70, v56, v37
    v_fmac_f32 v71, v49, v38
    v_fmac_f32 v70, v57, v39
    v_fmac_f32 v71, v50, v40
    v_fmac_f32 v70, v58, v41
    v_fmac_f32 v71, v51, v42
    v_fmac_f32 v70, v59, v43
    s_cmp_eq_u32 s69, 0
    s_cbranch_scc1 L_nds
    buffer_load_dwordx4 v[36:39], v84, s[24:27], 0 offen sc1
    buffer_load_dwordx4 v[40:43], v85, s[24:27], 0 offen sc1
L_nds:
    v_fmac_f32 v69, v44, v86
    v_fmac_f32 v68, v52, v87
    v_fmac_f32 v69, v45, v88
    v_fmac_f32 v68, v53, v89
    v_fmac_f32 v69, v46, v90
    v_fmac_f32 v68, v54, v91
    v_fmac_f32 v69, v47, v92
    v_fmac_f32 v68, v55, v93
    s_cmp_lg_u32 s3, 0
    s_cbranch_scc1 L_ressig
    s_cmp_gt_u32 s56, 4
    s_cbranch_scc1 L_bodyD
    s_cmp_lg_u32 s56, 0
    s_cbranch_scc1 L_pull
    s_branch L_flush
L_bodyP:
    s_min_u32 s57, s56, 4
    s_sub_u32 s56, s56, s57
    s_min_u32 s58, s56, 4
    s_cmp_eq_u32 s56, 0
    s_cselect_b32 s58, s61, s58
    s_waitcnt lgkmcnt(0)
    v_mfma_f32_16x16x16_bf16 v[44:47], v[72:73], v[4:5], 0
    v_mfma_f32_16x16x16_bf16 v[48:51], v[72:73], v[6:7], 0
    v_mfma_f32_16x16x16_bf16 v[52:55], v[72:73], v[8:9], 0
    v_mfma_f32_16x16x16_bf16 v[56:59], v[72:73], v[10:11], 0
    ds_read_b64 v[76:77], v98
    ds_read_u16 v78, v99 offset:6
    ds_read_b64_tr_b16 v[74:75], v100
    v_add_u32 v98, 8, v98
    v_add_u32 v99, 32, v99
    v_add_u32 v100, v102, v100
    s_mov_b32 s68, s64
    s_cmp_lg_u32 s64, 0
    s_cbranch_scc1 L_w1P
    s_waitcnt vmcnt(0)
L_w1P:
    s_waitcnt vmcnt(3) lgkmcnt(1)
    s_mov_b32 s64, 0
    v_add_u32 v79, v78, v105
    v_mad_u32_u16 v80, v76, v2, v103 op_sel:[0,0,0,0]
    v_mad_u32_u16 v81, v76, v2, v103 op_sel:[1,0,0,0]
    v_mad_u32_u16 v82, v77, v2, v103 op_sel:[0,0,0,0]
    v_mad_u32_u16 v83, v77, v2, v103 op_sel:[1,0,0,0]
    ds_read_b64 v[72:73], v79
    v_lshlrev_b64 v[86:87], 16, v[20:21]
    v_lshlrev_b64 v[88:89], 16, v[22:23]
    v_fmac_f32 v61, v44, v20
    v_fmac_f32 v62, v44, v21
    v_fmac_f32 v65, v48, v22
    v_fmac_f32 v66, v48, v23
    v_fmac_f32 v60, v44, v87
    v_fmac_f32 v64, v48, v89
    v_mul_f32 v52, v52, v86
    v_mul_f32 v56, v56, v88
L_ncP0:
    s_cmp_le_u32 s58, 0
    s_cbranch_scc1 L_nlP0
    buffer_load_dwordx4 v[20:23], v80, s[20:23], 0 offen sc1
L_nlP0:
    s_cmp_le_u32 s57, 1
    s_cbranch_scc1 L_ncP1
    v_lshlrev_b64 v[90:91], 16, v[24:25]
    v_lshlrev_b64 v[92:93], 16, v[26:27]
    v_fmac_f32 v61, v45, v24
    v_fmac_f32 v62, v45, v25
    v_fmac_f32 v65, v49, v26
    v_fmac_f32 v66, v49, v27
    v_fmac_f32 v60, v45, v91
    v_fmac_f32 v64, v49, v93
    v_mul_f32 v53, v53, v90
    v_mul_f32 v57, v57, v92
L_ncP1:
    s_cmp_le_u32 s58, 1
    s_cbranch_scc1 L_nlP1
    buffer_load_dwordx4 v[24:27], v81, s[20:23], 0 offen sc1
L_nlP1:
    s_cmp_le_u32 s57, 2
    s_cbranch_scc1 L_ncP2
    v_lshlrev_b64 v[86:87], 16, v[28:29]
    v_lshlrev_b64 v[88:89], 16, v[30:31]
    v_fmac_f32 v61, v46, v28
    v_fmac_f32 v62, v46, v29
    v_fmac_f32 v65, v50, v30
    v_fmac_f32 v66, v50, v31
    v_fmac_f32 v60, v46, v87
    v_fmac_f32 v64, v50, v89
    v_mul_f32 v54, v54, v86
    v_mul_f32 v58, v58, v88
L_ncP2:
    s_cmp_le_u32 s58, 2
    s_cbranch_scc1 L_nlP2
    buffer_load_dwordx4 v[28:31], v82, s[20:23], 0 offen sc1
L_nlP2:
    s_cmp_le_u32 s57, 3
    s_cbranch_scc1 L_ncP3
    v_lshlrev_b64 v[90:91], 16, v[32:33]
    v_lshlrev_b64 v[92:93], 16, v[34:35]
    v_fmac_f32 v61, v47, v32
    v_fmac_f32 v62, v47, v33
    v_fmac_f32 v65, v51, v34
    v_fmac_f32 v66, v51, v35
    v_fmac_f32 v60, v47, v91
    v_fmac_f32 v64, v51, v93
    v_mul_f32 v55, v55, v90
    v_mul_f32 v59, v59, v92
L_ncP3:
    s_cmp_le_u32 s58, 3
    s_cbranch_scc1 L_nlP3
    buffer_load_dwordx4 v[32:35], v83, s[20:23], 0 offen sc1
L_nlP3:
    v_cvt_pk_bf16_f32 v94, v52, v53
    v_cvt_pk_bf16_f32 v95, v54, v55
    v_cvt_pk_bf16_f32 v96, v56, v57
    v_cvt_pk_bf16_f32 v97, v58, v59
    s_waitcnt lgkmcnt(1)
    v_mfma_f32_16x16x16_bf16 v[60:63], v[74:75], v[94:95], v[60:63]
    v_mfma_f32_16x16x16_bf16 v[64:67], v[74:75], v[96:97], v[64:67]
    s_cmp_lg_u32 s3, 0
    s_cbranch_scc1 L_ressig
    s_cmp_gt_u32 s56, 4
    s_cbranch_scc1 L_bodyP
    s_cmp_lg_u32 s56, 0
    s_cbranch_scc1 L_pull
    s_cmp_eq_u32 s69, 0
    s_cbranch_scc1 L_flush
    v_bfe_u32 v84, v76, v113, 16
    v_lshl_add_u32 v84, v84, 7, v104
    v_bfe_u32 v85, v77, v113, 16
    v_lshl_add_u32 v85, v85, 7, v104
    buffer_load_dwordx4 v[36:39], v84, s[24:27], 0 offen sc1
    buffer_load_dwordx4 v[40:43], v85, s[24:27], 0 offen sc1
L_flush:
    s_cmp_lg_u32 s71, 0
    s_cbranch_scc1 L_coldres
L_fl1:
    s_or_b32 s65, s15, s16
    s_or_b32 s65, s65, s17
    s_cbranch_scc1 L_multi
L_fin:
    v_add_u32 v86, v106, v0
    s_nop 2
    v_cvt_pk_bf16_f32 v44, v60, v64
    v_lshlrev_b32 v45, 16, v110
    v_and_b32 v46, 0xffff0000, v110
    v_lshlrev_b32 v47, 16, v44
    v_and_b32 v44, 0xffff0000, v44
    v_add_f32 v45, v45, v47
    v_add_f32 v46, v46, v44
    v_cvt_pk_bf16_f32 v48, v45, v46
    v_cvt_pk_bf16_f32 v44, v61, v65
    v_lshlrev_b32 v45, 16, v111
    v_and_b32 v46, 0xffff0000, v111
    v_lshlrev_b32 v47, 16, v44
    v_and_b32 v44, 0xffff0000, v44
    v_add_f32 v45, v45, v47
    v_add_f32 v46, v46, v44
    v_cvt_pk_bf16_f32 v49, v45, v46
    v_cvt_pk_bf16_f32 v44, v62, v66
    v_lshlrev_b32 v45, 16, v112
    v_and_b32 v46, 0xffff0000, v112
    v_lshlrev_b32 v47, 16, v44
    v_and_b32 v44, 0xffff0000, v44
    v_add_f32 v45, v45, v47
    v_add_f32 v46, v46, v44
    v_cvt_pk_bf16_f32 v50, v45, v46
    s_cmp_eq_u32 s70, 0
    s_cbranch_scc1 L_fl2
    v_add_u32 v87, v106, v1
    v_cvt_pk_bf16_f32 v44, v69, v71
    v_lshlrev_b32 v45, 16, v108
    v_and_b32 v46, 0xffff0000, v108
    v_lshlrev_b32 v47, 16, v44
    v_and_b32 v44, 0xffff0000, v44
    v_add_f32 v45, v45, v47
    v_add_f32 v46, v46, v44
    v_cvt_pk_bf16_f32 v52, v45, v46
    v_cvt_pk_bf16_f32 v44, v68, v70
    v_lshlrev_b32 v45, 16, v109
    v_and_b32 v46, 0xffff0000, v109
    v_lshlrev_b32 v47, 16, v44
    v_and_b32 v44, 0xffff0000, v44
    v_add_f32 v45, v45, v47
    v_add_f32 v46, v46, v44
    v_cvt_pk_bf16_f32 v53, v45, v46
    buffer_store_dwordx2 v[52:53], v87, s[32:35], 0 offen nt
L_fl2:
    buffer_store_dword v48, v86, s[32:35], 0 offen offset:0 nt
    buffer_store_dword v49, v86, s[32:35], 0 offen offset:256 nt
    buffer_store_dword v50, v86, s[32:35], 0 offen offset:512 nt
    s_branch L_group
L_dwx:
    s_cmp_eq_u32 s58, 3
    s_cbranch_scc1 L_dx3
    s_cmp_eq_u32 s58, 2
    s_cbranch_scc1 L_dx2
    s_cmp_eq_u32 s58, 1
    s_cbranch_scc1 L_dx1
    s_waitcnt vmcnt(0)
L_dx1:
    s_waitcnt vmcnt(1)
L_dx2:
    s_waitcnt vmcnt(2)
L_dx3:
    s_waitcnt vmcnt(3)
    s_branch L_dw7
L_fw:
    s_waitcnt vmcnt(0)
    s_branch L_fl1
L_done:
    s_or_b32 s65, s16, s17
    s_cbranch_scc1 L_more
    s_endpgm
L_more:
    s_mov_b32 s15, 1
    s_cmp_lg_u32 s17, 0
    s_cselect_b32 s65, 0, 84
    s_add_u32 s14, s14, s65
    s_waitcnt vmcnt(0) lgkmcnt(0)
    s_barrier
    s_branch L_round
L_maskdone:
    v_and_b32 v50, 1, v127
    v_cmp_eq_u32 vcc, 0, v50
    s_nop 0
    s_and_b64 s[44:45], s[44:45], vcc
    v_and_b32 v50, 2, v127
    v_cmp_eq_u32 vcc, 0, v50
    s_nop 0
    s_and_b64 s[46:47], s[46:47], vcc
    v_and_b32 v50, 4, v127
    v_cmp_eq_u32 vcc, 0, v50
    s_nop 0
    s_and_b64 s[48:49], s[48:49], vcc
    v_and_b32 v50, 8, v127
    v_cmp_eq_u32 vcc, 0, v50
    s_nop 0
    s_and_b64 s[50:51], s[50:51], vcc
    v_and_b32 v50, 16, v127
    v_cmp_eq_u32 vcc, 0, v50
    s_nop 0
    s_and_b64 s[52:53], s[52:53], vcc
    v_and_b32 v50, 32, v127
    v_cmp_eq_u32 vcc, 0, v50
    s_nop 0
    s_and_b64 s[54:55], s[54:55], vcc
    v_and_b32 v50, 64, v127
    v_cmp_eq_u32 vcc, 0, v50
    s_nop 0
    s_and_b64 s[56:57], s[56:57], vcc
    s_branch L_maskret
L_sort:
    v_lshrrev_b32 v36, 3, v103
    v_add_u32 v20, v98, v36
    v_mul_u32_u24 v21, s67, v116
    v_add_u32 v21, 69632, v21
    v_lshl_add_u32 v37, v36, 2, v21
    ds_read_u16 v22, v20
    ds_read_u16 v23, v20 offset:32
    ds_read_u16 v24, v20 offset:64
    ds_read_b64 v[28:29], v37
    ds_read_b64 v[30:31], v37 offset:128
    ds_read_b64 v[32:33], v37 offset:256
    s_mov_b32 s65, 0xffff
    s_mov_b32 s66, 0x01010100
    s_waitcnt lgkmcnt(3)
    v_cmp_ne_u32 s[44:45], s65, v22
    v_mul_u32_u24 v38, 6711, v22
    v_lshrrev_b32 v38, 24, v38
    v_lshlrev_b32 v38, 3, v38
    v_cndmask_b32 v25, 0, 1, s[44:45]
    v_lshlrev_b32 v25, v38, v25
    v_cmp_ne_u32 s[46:47], s65, v23
    v_mul_u32_u24 v39, 6711, v23
    v_lshrrev_b32 v39, 24, v39
    v_lshlrev_b32 v39, 3, v39
    v_cndmask_b32 v26, 0, 1, s[46:47]
    v_lshlrev_b32 v26, v39, v26
    v_cmp_ne_u32 s[48:49], s65, v24
    v_mul_u32_u24 v40, 6711, v24
    v_lshrrev_b32 v40, 24, v40
    v_lshlrev_b32 v40, 3, v40
    v_cndmask_b32 v27, 0, 1, s[48:49]
    v_lshlrev_b32 v27, v40, v27
    v_add3_u32 v36, v25, v26, v27
    v_mov_b32 v37, v36
    s_nop 1
    v_add_u32_dpp v37, v37, v37 row_shr:1 row_mask:0xf bank_mask:0xf
    s_nop 1
    v_add_u32_dpp v37, v37, v37 row_shr:2 row_mask:0xf bank_mask:0xf
    s_nop 1
    v_add_u32_dpp v37, v37, v37 row_shr:4 row_mask:0xf bank_mask:0xf
    s_nop 1
    v_add_u32_dpp v37, v37, v37 row_shr:8 row_mask:0xf bank_mask:0xf
    s_nop 1
    v_mov_b32_dpp v41, v37 row_newbcast:15 row_mask:0xf bank_mask:0xf
    v_sub_u32 v37, v37, v36
    v_mul_lo_u32 v41, v41, s66
    v_add_u32 v37, v37, v41
    s_waitcnt lgkmcnt(0)
    v_bfe_u32 v41, v37, v38, 8
    v_add_u32 v37, v37, v25
    v_lshl_add_u32 v42, v41, 1, v98
    v_lshl_add_u32 v43, v41, 3, v21
    s_mov_b64 exec, s[44:45]
    ds_write_b16 v42, v22
    ds_write_b64 v43, v[28:29]
    s_mov_b64 exec, -1
    v_bfe_u32 v41, v37, v39, 8
    v_add_u32 v37, v37, v26
    v_lshl_add_u32 v42, v41, 1, v98
    v_lshl_add_u32 v43, v41, 3, v21
    s_mov_b64 exec, s[46:47]
    ds_write_b16 v42, v23
    ds_write_b64 v43, v[30:31]
    s_mov_b64 exec, -1
    v_bfe_u32 v41, v37, v40, 8
    v_add_u32 v37, v37, v27
    v_lshl_add_u32 v42, v41, 1, v98
    v_lshl_add_u32 v43, v41, 3, v21
    s_mov_b64 exec, s[48:49]
    ds_write_b16 v42, v24
    ds_write_b64 v43, v[32:33]
    s_mov_b64 exec, -1
    s_branch L_group
L_multi:
    v_lshl_add_u32 v86, v103, 2, v106
    s_cmp_eq_u32 s15, 0
    s_cbranch_scc1 L_m1
    buffer_load_dwordx4 v[44:47], v86, s[40:43], 0 offen sc1
    buffer_load_dwordx4 v[48:51], v86, s[40:43], 0 offen offset:16 sc1
    buffer_load_dwordx4 v[52:55], v86, s[40:43], 0 offen offset:32 sc1
    s_waitcnt vmcnt(0)
    v_add_f32 v60, v60, v44
    v_add_f32 v61, v61, v45
    v_add_f32 v62, v62, v46
    v_add_f32 v63, v63, v47
    v_add_f32 v64, v64, v48
    v_add_f32 v65, v65, v49
    v_add_f32 v66, v66, v50
    v_add_f32 v67, v67, v51
    v_add_f32 v68, v68, v52
    v_add_f32 v69, v69, v53
    v_add_f32 v70, v70, v54
    v_add_f32 v71, v71, v55
L_m1:
    s_or_b32 s65, s16, s17
    s_cbranch_scc0 L_fin
    s_nop 4
    buffer_store_dwordx4 v[60:63], v86, s[40:43], 0 offen sc1
    buffer_store_dwordx4 v[64:67], v86, s[40:43], 0 offen offset:16 sc1
    buffer_store_dwordx4 v[68:71], v86, s[40:43], 0 offen offset:32 sc1
    s_waitcnt vmcnt(0)
    s_branch L_group
L_resforce:
    s_waitcnt vmcnt(0)
    s_mov_b32 s3, 3
L_ressig:
    s_bitcmp0_b32 s3, 0
    s_cbranch_scc1 L_heavy
    s_mov_b64 exec, 1
    ds_add_u32 v119, v118 offset:20
    s_mov_b64 exec, -1
    s_bitcmp1_b32 s3, 1
    s_cselect_b32 s65, 1, 0
    s_and_b32 s3, s3, 4
    s_cmp_lg_u32 s65, 0
    s_cbranch_scc1 L_pull1
L_resret:
    s_cmp_gt_u32 s56, 4
    s_cbranch_scc1 L_disp
    s_branch L_pull
L_heavy:
    s_cmp_gt_u32 s56, s54
    s_cbranch_scc1 L_resret
    s_cmp_lg_u32 s56, s54
    s_cbranch_scc1 L_hv2
    s_lshl_b32 s65, s53, 4
    v_add_u32 v114, s65, v122
    v_add_u32 v115, s65, v123
    ds_read_b32 v114, v114
    ds_read_b32 v115, v115
    ds_read_b64 v[116:117], v119 offset:32
    s_movk_i32 s66, 96
    s_movk_i32 s67, 384
    v_mov_b32 v86, 0x9f
    v_mov_b32 v87, 0x9d
    v_mov_b32 v88, 0x9e
    s_waitcnt lgkmcnt(0)
    v_and_b32 v114, 0xff, v114
    v_mad_u32_u24 v114, v114, 48, 1
    v_cmp_eq_u32 vcc, v114, v116
    s_nop 1
    v_cndmask_b32 v89, v86, v87, vcc
    v_cmp_eq_u32 vcc, v114, v117
    s_nop 1
    v_cndmask_b32 v114, v89, v88, vcc
    v_and_b32 v115, 0xff, v115
    v_mad_u32_u24 v115, v115, 48, 1
    v_cmp_eq_u32 vcc, v115, v116
    s_nop 1
    v_cndmask_b32 v89, v86, v87, vcc
    v_cmp_eq_u32 vcc, v115, v117
    s_nop 1
    v_cndmask_b32 v115, v89, v88, vcc
    v_mul_u32_u24 v98, s66, v114
    v_add_u32 v98, 135168, v98
    v_mad_u32_u24 v99, v115, s67, v124
    v_mad_u32_u24 v110, v114, v126, v125
    s_branch L_disp
L_hv2:
    v_mov_b32 v100, v110
    s_mov_b32 s3, 0
    s_branch L_resret
L_ext:
    s_mov_b64 s[66:67], 0
    v_mov_b32 v60, 0
    s_mov_b64 exec, s[44:45]
    s_cbranch_execz L_ex0
    v_mov_b32 v60, 0
    v_sub_u32 v58, v50, v67
    v_add_u32 v58, 1, v58
    ds_cmpst_rtn_b32 v59, v119, v60, v58 offset:32
    v_mov_b32 v61, 7488
    s_waitcnt lgkmcnt(0)
    v_cmp_ne_u32 vcc, 0, v59
    v_cmp_ne_u32 s[68:69], v58, v59
    s_nop 0
    s_and_b64 exec, vcc, s[68:69]
    ds_cmpst_rtn_b32 v59, v119, v60, v58 offset:36
    v_mov_b32 v61, 7536
    s_waitcnt lgkmcnt(0)
    v_cmp_ne_u32 vcc, 0, v59
    v_cmp_ne_u32 s[68:69], v58, v59
    s_nop 0
    s_and_b64 s[68:69], vcc, s[68:69]
    s_mov_b64 exec, s[44:45]
    v_cmp_le_u32 vcc, 96, v67
    s_nop 0
    s_or_b64 s[68:69], s[68:69], vcc
    s_or_b64 s[66:67], s[66:67], s[68:69]
    s_andn2_b64 exec, exec, s[68:69]
    v_add_u32 v61, v61, v67
    v_lshl_add_u32 v58, v61, 3, s72
    v_lshl_add_u32 v59, v61, 1, s73
    ds_write_b64 v58, v[64:65]
    ds_write_b16 v59, v66
    v_or_b32 v127, 1, v127
L_ex0:
    s_mov_b64 exec, s[46:47]
    s_cbranch_execz L_ex1
    v_mov_b32 v60, 0
    v_sub_u32 v58, v51, v71
    v_add_u32 v58, 1, v58
    ds_cmpst_rtn_b32 v59, v119, v60, v58 offset:32
    v_mov_b32 v61, 7488
    s_waitcnt lgkmcnt(0)
    v_cmp_ne_u32 vcc, 0, v59
    v_cmp_ne_u32 s[68:69], v58, v59
    s_nop 0
    s_and_b64 exec, vcc, s[68:69]
    ds_cmpst_rtn_b32 v59, v119, v60, v58 offset:36
    v_mov_b32 v61, 7536
    s_waitcnt lgkmcnt(0)
    v_cmp_ne_u32 vcc, 0, v59
    v_cmp_ne_u32 s[68:69], v58, v59
    s_nop 0
    s_and_b64 s[68:69], vcc, s[68:69]
    s_mov_b64 exec, s[46:47]
    v_cmp_le_u32 vcc, 96, v71
    s_nop 0
    s_or_b64 s[68:69], s[68:69], vcc
    s_or_b64 s[66:67], s[66:67], s[68:69]
    s_andn2_b64 exec, exec, s[68:69]
    v_add_u32 v61, v61, v71
    v_lshl_add_u32 v58, v61, 3, s72
    v_lshl_add_u32 v59, v61, 1, s73
    ds_write_b64 v58, v[68:69]
    ds_write_b16 v59, v70
    v_or_b32 v127, 2, v127
L_ex1:
    s_mov_b64 exec, s[48:49]
    s_cbranch_execz L_ex2
    v_mov_b32 v60, 0
    v_sub_u32 v58, v52, v75
    v_add_u32 v58, 1, v58
    ds_cmpst_rtn_b32 v59, v119, v60, v58 offset:32
    v_mov_b32 v61, 7488
    s_waitcnt lgkmcnt(0)
    v_cmp_ne_u32 vcc, 0, v59
    v_cmp_ne_u32 s[68:69], v58, v59
    s_nop 0
    s_and_b64 exec, vcc, s[68:69]
    ds_cmpst_rtn_b32 v59, v119, v60, v58 offset:36
    v_mov_b32 v61, 7536
    s_waitcnt lgkmcnt(0)
    v_cmp_ne_u32 vcc, 0, v59
    v_cmp_ne_u32 s[68:69], v58, v59
    s_nop 0
    s_and_b64 s[68:69], vcc, s[68:69]
    s_mov_b64 exec, s[48:49]
    v_cmp_le_u32 vcc, 96, v75
    s_nop 0
    s_or_b64 s[68:69], s[68:69], vcc
    s_or_b64 s[66:67], s[66:67], s[68:69]
    s_andn2_b64 exec, exec, s[68:69]
    v_add_u32 v61, v61, v75
    v_lshl_add_u32 v58, v61, 3, s72
    v_lshl_add_u32 v59, v61, 1, s73
    ds_write_b64 v58, v[72:73]
    ds_write_b16 v59, v74
    v_or_b32 v127, 4, v127
L_ex2:
    s_mov_b64 exec, s[50:51]
    s_cbranch_execz L_ex3
    v_mov_b32 v60, 0
    v_sub_u32 v58, v53, v79
    v_add_u32 v58, 1, v58
    ds_cmpst_rtn_b32 v59, v119, v60, v58 offset:32
    v_mov_b32 v61, 7488
    s_waitcnt lgkmcnt(0)
    v_cmp_ne_u32 vcc, 0, v59
    v_cmp_ne_u32 s[68:69], v58, v59
    s_nop 0
    s_and_b64 exec, vcc, s[68:69]
    ds_cmpst_rtn_b32 v59, v119, v60, v58 offset:36
    v_mov_b32 v61, 7536
    s_waitcnt lgkmcnt(0)
    v_cmp_ne_u32 vcc, 0, v59
    v_cmp_ne_u32 s[68:69], v58, v59
    s_nop 0
    s_and_b64 s[68:69], vcc, s[68:69]
    s_mov_b64 exec, s[50:51]
    v_cmp_le_u32 vcc, 96, v79
    s_nop 0
    s_or_b64 s[68:69], s[68:69], vcc
    s_or_b64 s[66:67], s[66:67], s[68:69]
    s_andn2_b64 exec, exec, s[68:69]
    v_add_u32 v61, v61, v79
    v_lshl_add_u32 v58, v61, 3, s72
    v_lshl_add_u32 v59, v61, 1, s73
    ds_write_b64 v58, v[76:77]
    ds_write_b16 v59, v78
    v_or_b32 v127, 8, v127
L_ex3:
    s_mov_b64 exec, s[52:53]
    s_cbranch_execz L_ex4
    v_mov_b32 v60, 0
    v_sub_u32 v58, v54, v83
    v_add_u32 v58, 1, v58
    ds_cmpst_rtn_b32 v59, v119, v60, v58 offset:32
    v_mov_b32 v61, 7488
    s_waitcnt lgkmcnt(0)
    v_cmp_ne_u32 vcc, 0, v59
    v_cmp_ne_u32 s[68:69], v58, v59
    s_nop 0
    s_and_b64 exec, vcc, s[68:69]
    ds_cmpst_rtn_b32 v59, v119, v60, v58 offset:36
    v_mov_b32 v61, 7536
    s_waitcnt lgkmcnt(0)
    v_cmp_ne_u32 vcc, 0, v59
    v_cmp_ne_u32 s[68:69], v58, v59
    s_nop 0
    s_and_b64 s[68:69], vcc, s[68:69]
    s_mov_b64 exec, s[52:53]
    v_cmp_le_u32 vcc, 96, v83
    s_nop 0
    s_or_b64 s[68:69], s[68:69], vcc
    s_or_b64 s[66:67], s[66:67], s[68:69]
    s_andn2_b64 exec, exec, s[68:69]
    v_add_u32 v61, v61, v83
    v_lshl_add_u32 v58, v61, 3, s72
    v_lshl_add_u32 v59, v61, 1, s73
    ds_write_b64 v58, v[80:81]
    ds_write_b16 v59, v82
    v_or_b32 v127, 16, v127
L_ex4:
    s_mov_b64 exec, s[54:55]
    s_cbranch_execz L_ex5
    v_mov_b32 v60, 0
    v_sub_u32 v58, v55, v87
    v_add_u32 v58, 1, v58
    ds_cmpst_rtn_b32 v59, v119, v60, v58 offset:32
    v_mov_b32 v61, 7488
    s_waitcnt lgkmcnt(0)
    v_cmp_ne_u32 vcc, 0, v59
    v_cmp_ne_u32 s[68:69], v58, v59
    s_nop 0
    s_and_b64 exec, vcc, s[68:69]
    ds_cmpst_rtn_b32 v59, v119, v60, v58 offset:36
    v_mov_b32 v61, 7536
    s_waitcnt lgkmcnt(0)
    v_cmp_ne_u32 vcc, 0, v59
    v_cmp_ne_u32 s[68:69], v58, v59
    s_nop 0
    s_and_b64 s[68:69], vcc, s[68:69]
    s_mov_b64 exec, s[54:55]
    v_cmp_le_u32 vcc, 96, v87
    s_nop 0
    s_or_b64 s[68:69], s[68:69], vcc
    s_or_b64 s[66:67], s[66:67], s[68:69]
    s_andn2_b64 exec, exec, s[68:69]
    v_add_u32 v61, v61, v87
    v_lshl_add_u32 v58, v61, 3, s72
    v_lshl_add_u32 v59, v61, 1, s73
    ds_write_b64 v58, v[84:85]
    ds_write_b16 v59, v86
    v_or_b32 v127, 32, v127
L_ex5:
    s_mov_b64 exec, s[56:57]
    s_cbranch_execz L_ex6
    v_mov_b32 v60, 0
    v_sub_u32 v58, v56, v91
    v_add_u32 v58, 1, v58
    ds_cmpst_rtn_b32 v59, v119, v60, v58 offset:32
    v_mov_b32 v61, 7488
    s_waitcnt lgkmcnt(0)
    v_cmp_ne_u32 vcc, 0, v59
    v_cmp_ne_u32 s[68:69], v58, v59
    s_nop 0
    s_and_b64 exec, vcc, s[68:69]
    ds_cmpst_rtn_b32 v59, v119, v60, v58 offset:36
    v_mov_b32 v61, 7536
    s_waitcnt lgkmcnt(0)
    v_cmp_ne_u32 vcc, 0, v59
    v_cmp_ne_u32 s[68:69], v58, v59
    s_nop 0
    s_and_b64 s[68:69], vcc, s[68:69]
    s_mov_b64 exec, s[56:57]
    v_cmp_le_u32 vcc, 96, v91
    s_nop 0
    s_or_b64 s[68:69], s[68:69], vcc
    s_or_b64 s[66:67], s[66:67], s[68:69]
    s_andn2_b64 exec, exec, s[68:69]
    v_add_u32 v61, v61, v91
    v_lshl_add_u32 v58, v61, 3, s72
    v_lshl_add_u32 v59, v61, 1, s73
    ds_write_b64 v58, v[88:89]
    ds_write_b16 v59, v90
    v_or_b32 v127, 64, v127
L_ex6:
    s_mov_b64 exec, s[66:67]
    ds_write_b32 v119, v118 offset:8
    s_branch L_extret
L_cp:
    s_mov_b32 s73, 0xffff
    s_mov_b64 exec, s[44:45]
    v_subrev_u32 v58, 67108864, v65
    v_cmp_gt_u32 vcc, s72, v58
    s_nop 0
    s_and_b64 exec, exec, vcc
    s_cbranch_execz L_cq0
    ds_add_rtn_u32 v59, v119, v118 offset:28
    v_lshrrev_b32 v58, 16, v65
    buffer_load_dwordx4 v[20:23], v58, s[36:39], 0 offen sc1
    buffer_load_dwordx4 v[24:27], v58, s[36:39], 0 offen offset:16 sc1
    s_waitcnt vmcnt(0) lgkmcnt(0)
    v_cmp_gt_u32 vcc, 52, v59
    s_nop 0
    s_andn2_b64 exec, exec, vcc
    ds_write_b32 v119, v118 offset:4
    s_mov_b64 exec, vcc
    v_lshlrev_b32 v59, 5, v59
    v_add_u32 v59, 63872, v59
    ds_write_b128 v59, v[20:23]
    ds_write_b128 v59, v[24:27] offset:16
    v_lshlrev_b32 v59, 16, v59
    v_and_or_b32 v65, v65, s73, v59
L_cq0:
    s_mov_b64 exec, s[46:47]
    v_subrev_u32 v58, 67108864, v69
    v_cmp_gt_u32 vcc, s72, v58
    s_nop 0
    s_and_b64 exec, exec, vcc
    s_cbranch_execz L_cq1
    ds_add_rtn_u32 v59, v119, v118 offset:28
    v_lshrrev_b32 v58, 16, v69
    buffer_load_dwordx4 v[20:23], v58, s[36:39], 0 offen sc1
    buffer_load_dwordx4 v[24:27], v58, s[36:39], 0 offen offset:16 sc1
    s_waitcnt vmcnt(0) lgkmcnt(0)
    v_cmp_gt_u32 vcc, 52, v59
    s_nop 0
    s_andn2_b64 exec, exec, vcc
    ds_write_b32 v119, v118 offset:4
    s_mov_b64 exec, vcc
    v_lshlrev_b32 v59, 5, v59
    v_add_u32 v59, 63872, v59
    ds_write_b128 v59, v[20:23]
    ds_write_b128 v59, v[24:27] offset:16
    v_lshlrev_b32 v59, 16, v59
    v_and_or_b32 v69, v69, s73, v59
L_cq1:
    s_mov_b64 exec, s[48:49]
    v_subrev_u32 v58, 67108864, v73
    v_cmp_gt_u32 vcc, s72, v58
    s_nop 0
    s_and_b64 exec, exec, vcc
    s_cbranch_execz L_cq2
    ds_add_rtn_u32 v59, v119, v118 offset:28
    v_lshrrev_b32 v58, 16, v73
    buffer_load_dwordx4 v[20:23], v58, s[36:39], 0 offen sc1
    buffer_load_dwordx4 v[24:27], v58, s[36:39], 0 offen offset:16 sc1
    s_waitcnt vmcnt(0) lgkmcnt(0)
    v_cmp_gt_u32 vcc, 52, v59
    s_nop 0
    s_andn2_b64 exec, exec, vcc
    ds_write_b32 v119, v118 offset:4
    s_mov_b64 exec, vcc
    v_lshlrev_b32 v59, 5, v59
    v_add_u32 v59, 63872, v59
    ds_write_b128 v59, v[20:23]
    ds_write_b128 v59, v[24:27] offset:16
    v_lshlrev_b32 v59, 16, v59
    v_and_or_b32 v73, v73, s73, v59
L_cq2:
    s_mov_b64 exec, s[50:51]
    v_subrev_u32 v58, 67108864, v77
    v_cmp_gt_u32 vcc, s72, v58
    s_nop 0
    s_and_b64 exec, exec, vcc
    s_cbranch_execz L_cq3
    ds_add_rtn_u32 v59, v119, v118 offset:28
    v_lshrrev_b32 v58, 16, v77
    buffer_load_dwordx4 v[20:23], v58, s[36:39], 0 offen sc1
    buffer_load_dwordx4 v[24:27], v58, s[36:39], 0 offen offset:16 sc1
    s_waitcnt vmcnt(0) lgkmcnt(0)
    v_cmp_gt_u32 vcc, 52, v59
    s_nop 0
    s_andn2_b64 exec, exec, vcc
    ds_write_b32 v119, v118 offset:4
    s_mov_b64 exec, vcc
    v_lshlrev_b32 v59, 5, v59
    v_add_u32 v59, 63872, v59
    ds_write_b128 v59, v[20:23]
    ds_write_b128 v59, v[24:27] offset:16
    v_lshlrev_b32 v59, 16, v59
    v_and_or_b32 v77, v77, s73, v59
L_cq3:
    s_mov_b64 exec, s[52:53]
    v_subrev_u32 v58, 67108864, v81
    v_cmp_gt_u32 vcc, s72, v58
    s_nop 0
    s_and_b64 exec, exec, vcc
    s_cbranch_execz L_cq4
    ds_add_rtn_u32 v59, v119, v118 offset:28
    v_lshrrev_b32 v58, 16, v81
    buffer_load_dwordx4 v[20:23], v58, s[36:39], 0 offen sc1
    buffer_load_dwordx4 v[24:27], v58, s[36:39], 0 offen offset:16 sc1
    s_waitcnt vmcnt(0) lgkmcnt(0)
    v_cmp_gt_u32 vcc, 52, v59
    s_nop 0
    s_andn2_b64 exec, exec, vcc
    ds_write_b32 v119, v118 offset:4
    s_mov_b64 exec, vcc
    v_lshlrev_b32 v59, 5, v59
    v_add_u32 v59, 63872, v59
    ds_write_b128 v59, v[20:23]
    ds_write_b128 v59, v[24:27] offset:16
    v_lshlrev_b32 v59, 16, v59
    v_and_or_b32 v81, v81, s73, v59
L_cq4:
    s_mov_b64 exec, s[54:55]
    v_subrev_u32 v58, 67108864, v85
    v_cmp_gt_u32 vcc, s72, v58
    s_nop 0
    s_and_b64 exec, exec, vcc
    s_cbranch_execz L_cq5
    ds_add_rtn_u32 v59, v119, v118 offset:28
    v_lshrrev_b32 v58, 16, v85
    buffer_load_dwordx4 v[20:23], v58, s[36:39], 0 offen sc1
    buffer_load_dwordx4 v[24:27], v58, s[36:39], 0 offen offset:16 sc1
    s_waitcnt vmcnt(0) lgkmcnt(0)
    v_cmp_gt_u32 vcc, 52, v59
    s_nop 0
    s_andn2_b64 exec, exec, vcc
    ds_write_b32 v119, v118 offset:4
    s_mov_b64 exec, vcc
    v_lshlrev_b32 v59, 5, v59
    v_add_u32 v59, 63872, v59
    ds_write_b128 v59, v[20:23]
    ds_write_b128 v59, v[24:27] offset:16
    v_lshlrev_b32 v59, 16, v59
    v_and_or_b32 v85, v85, s73, v59
L_cq5:
    s_mov_b64 exec, s[56:57]
    v_subrev_u32 v58, 67108864, v89
    v_cmp_gt_u32 vcc, s72, v58
    s_nop 0
    s_and_b64 exec, exec, vcc
    s_cbranch_execz L_cq6
    ds_add_rtn_u32 v59, v119, v118 offset:28
    v_lshrrev_b32 v58, 16, v89
    buffer_load_dwordx4 v[20:23], v58, s[36:39], 0 offen sc1
    buffer_load_dwordx4 v[24:27], v58, s[36:39], 0 offen offset:16 sc1
    s_waitcnt vmcnt(0) lgkmcnt(0)
    v_cmp_gt_u32 vcc, 52, v59
    s_nop 0
    s_andn2_b64 exec, exec, vcc
    ds_write_b32 v119, v118 offset:4
    s_mov_b64 exec, vcc
    v_lshlrev_b32 v59, 5, v59
    v_add_u32 v59, 63872, v59
    ds_write_b128 v59, v[20:23]
    ds_write_b128 v59, v[24:27] offset:16
    v_lshlrev_b32 v59, 16, v59
    v_and_or_b32 v89, v89, s73, v59
L_cq6:
    s_branch L_cpret
L_coldload:
    s_waitcnt vmcnt(0)
    s_barrier
    v_mbcnt_lo_u32_b32 v114, -1, 0
    v_mbcnt_hi_u32_b32 v114, -1, v114
    s_lshl_b32 s65, s10, 11
    v_lshl_add_u32 v114, v114, 4, s65
    s_mov_b32 m0, s65
    s_nop 0
    buffer_load_dwordx4 v[44:47], v114, s[36:39], 0 offen sc1
    buffer_load_dwordx4 v[48:51], v114, s[36:39], 0 offen offset:1024 sc1
    s_waitcnt vmcnt(0)
    ds_write_b128 v114, v[44:47]
    ds_write_b128 v114, v[48:51] offset:1024
    s_waitcnt lgkmcnt(0)
    s_barrier
    s_branch L_desc
L_coldres:
    v_add_u32 v115, v106, v0
    buffer_load_dword v110, v115, s[28:31], 0 offen
    buffer_load_dword v111, v115, s[28:31], 0 offen offset:256
    buffer_load_dword v112, v115, s[28:31], 0 offen offset:512
    s_waitcnt vmcnt(0)
    s_branch L_fl1
L_end2:
L_end:
    s_endpgm
L_code_end:
.section .rodata,"a"
.p2align 6
.amdhsa_kernel standalone__molecular_angular_painn__graph_kernel
  .amdhsa_next_free_vgpr 128
  .amdhsa_next_free_sgpr 102
  .amdhsa_accum_offset 128
  .amdhsa_group_segment_fixed_size 0
  .amdhsa_kernarg_size 88
  .amdhsa_user_sgpr_count 2
  .amdhsa_user_sgpr_kernarg_segment_ptr 1
  .amdhsa_system_sgpr_workgroup_id_x 1
.end_amdhsa_kernel
```
